```python
import torch

def _softmax(x, axis=-1):
    return torch.softmax(x, dim=axis)
def _gelu(x):
    return torch.nn.functional.gelu(x, approximate="tanh")
def _silu(x):
    return torch.nn.functional.silu(x)
def _sigmoid(x):
    return torch.sigmoid(x)
def _layernorm(x, axis=-1, eps=1e-5):
    m = x.mean(dim=axis, keepdim=True)
    v = x.var(dim=axis, keepdim=True, unbiased=False)
    return (x - m) / torch.sqrt(v + eps)
def _scatter_add(tgt, idx, src, axis=0):
    return tgt.clone().index_add_(axis, idx, src)
def _segment_sum(src, seg, n):
    out = torch.zeros((n,) + src.shape[1:], dtype=src.dtype)
    return out.index_add_(0, seg, src)
def _pad(x, pw):
    flat = tuple(v for pair in reversed(pw) for v in pair)
    return torch.nn.functional.pad(x, flat)

kernel_name = 'sequential_preLN__softmax_full_mha__dense_activation_gelu__prompt'

def setup_inputs():

    _w = (lambda a: (lambda t: t.to(torch.bfloat16) if t.is_floating_point() else t)(torch.as_tensor(a)))
    def _A_setup():
        B, S, D = 1, 2048, 640
        return {
            "x": _w((lambda *s: torch.randn(*s, dtype=torch.bfloat16) * 0.05)(B, S, D)),
            "wqkv": _w((lambda *s: torch.randn(*s, dtype=torch.bfloat16) * 0.05)(D, 3 * D)),
            "wo": _w((lambda *s: torch.randn(*s, dtype=torch.bfloat16) * 0.05)(D, D)),
        }
    _A_in = _A_setup()

    def _B_setup():
        B, S, D, F = 1, 2048, 640, 1728
        return {
            "x": _w((lambda *s: torch.randn(*s, dtype=torch.bfloat16) * 0.05)(B, S, D)),
            "w1": _w((lambda *s: torch.randn(*s, dtype=torch.bfloat16) * 1.6)(D, F) * (D ** -0.5)),
            "b1": _w((lambda *s: torch.randn(*s, dtype=torch.bfloat16) * 1.6)(F) * 0.01),
            "w2": _w((lambda *s: torch.randn(*s, dtype=torch.bfloat16) * 0.2)(F, D) * (F ** -0.5)),
            "b2": _w((lambda *s: torch.randn(*s, dtype=torch.bfloat16) * 0.2)(D) * 0.01),
        }
    _B_in = _B_setup()

    return {
        "A_x": _A_in["x"],
        "A_wqkv": _A_in["wqkv"],
        "A_wo": _A_in["wo"],
        "B_x": _B_in["x"],
        "B_w1": _B_in["w1"],
        "B_b1": _B_in["b1"],
        "B_w2": _B_in["w2"],
        "B_b2": _B_in["b2"],
    }

def reference(A_x, A_wqkv, A_wo, B_x, B_w1, B_b1, B_w2, B_b2):
    def _A_ref(x, wqkv, wo):
        B, S, D = x.shape
        H = 32; Dh = D // H
        qkv = (lambda x, *d: x.permute(*d))((x @ wqkv).reshape(B, S, 3, H, Dh), 2, 0, 3, 1, 4)
        q, k, v = qkv[0], qkv[1], qkv[2]
        scale = Dh ** -0.5
        scores = torch.einsum("bhqd,bhkd->bhqk", q, k) * scale
        p = _softmax(scores, axis=-1)
        o = torch.einsum("bhqk,bhkd->bhqd", p, v)
        return (lambda x, *d: x.permute(*d))(o, 0, 2, 1, 3).reshape(B, S, D) @ wo

    def _B_ref(x, w1, b1, w2, b2):
        h = torch.einsum("bsd,df->bsf", x, w1) + b1
        h = _gelu(h)
        return torch.einsum("bsf,fd->bsd", h, w2) + b2

    x = A_x
    h = x + _A_ref(_layernorm(x, axis=-1), A_wqkv, A_wo)
    h2 = h + _B_ref(_layernorm(h, axis=-1), B_w1, B_b1, B_w2, B_b2)
    return h2
```

```asm
; @launch grid=(256,1,1) block=(512,1,1) lds=163840
.amdgcn_target "amdgcn-amd-amdhsa--gfx950"
.text
.globl sequential_preLN__softmax_full_mha__dense_activation_gelu__prompt_kernel
.p2align 8
.type sequential_preLN__softmax_full_mha__dense_activation_gelu__prompt_kernel,@function
sequential_preLN__softmax_full_mha__dense_activation_gelu__prompt_kernel:
    s_cmp_ge_u32 s2, 256
    s_cbranch_scc1 L_sequential_preLN__softmax_full_mha__dense_activation_gelu__prompt_kernel_end
    s_load_dwordx4 s[4:7], s[0:1], 0
    s_load_dwordx2 s[8:9], s[0:1], 80
    v_and_b32 v1, 63, v0
    v_lshrrev_b32 v2, 6, v0
    s_and_b32 s29, s2, 7
    s_lshr_b32 s28, s2, 3
    v_readfirstlane_b32 s30, v2
    v_lshlrev_b32 v6, 4, v1
    v_lshlrev_b32 v7, 3, v1
    s_and_b32 s56, s29, 1
    s_lshl_b32 s56, s56, 3
    s_and_b32 s32, s28, 7
    s_add_u32 s56, s56, s32
    s_lshr_b32 s57, s29, 1
    s_lshl_b32 s57, s57, 2
    s_lshr_b32 s32, s28, 3
    s_add_u32 s57, s57, s32
    s_and_b32 s63, s29, 1
    s_lshl_b32 s63, s63, 1
    s_bfe_u32 s32, s29, 0x10001
    s_add_u32 s63, s63, s32
    s_and_b32 s32, s29, 4
    s_add_u32 s63, s63, s32
    s_lshl_b32 s3, s29, 2
    s_and_b32 s32, s28, 3
    s_add_u32 s3, s3, s32
    s_lshr_b32 s100, s28, 2
    s_and_b32 s31, s30, 3
    s_cmp_lt_u32 s30, 4
    s_cbranch_scc1 L_A1
    s_cmp_lg_u32 s30, 5
    s_cbranch_scc1 L_ncw
    s_getpc_b64 s[10:11]
L_cpc:
    s_sub_u32 s10, s10, L_cpc - sequential_preLN__softmax_full_mha__dense_activation_gelu__prompt_kernel
    s_subb_u32 s11, s11, 0
    s_mul_i32 s32, s28, 52
    s_lshr_b32 s32, s32, 8
    s_mul_i32 s32, s32, 5
    s_sub_u32 s32, s28, s32
    s_lshl_b32 s32, s32, 13
    v_lshl_add_u32 v2, v1, 7, s32
    v_min_u32 v2, L_sequential_preLN__softmax_full_mha__dense_activation_gelu__prompt_kernel_end - sequential_preLN__softmax_full_mha__dense_activation_gelu__prompt_kernel, v2
    global_load_dword v24, v2, s[10:11]
L_ncw:
    s_add_u32 s32, s56, s57
    s_mul_i32 s33, s32, 342
    s_lshr_b32 s33, s33, 10
    s_mul_i32 s33, s33, 3
    s_sub_u32 s32, s32, s33
    s_lshl_b32 s32, s32, 2
    s_lshr_b32 s37, 1584, s32
    s_and_b32 s37, s37, 15
    s_cmp_ge_u32 s30, 6
    s_cbranch_scc1 L_BW
    s_movk_i32 s32, 1280
    s_cmp_ge_u32 s57, 10
    s_cselect_b32 s33, s32, 2560
    s_cselect_b32 s41, 40960, s32
    s_lshl_b32 s34, s33, 3
    s_sub_u32 s34, s34, 1024
    v_lshrrev_b32 v2, 3, v1
    v_mul_u32_u24 v2, s33, v2
    v_and_b32 v3, 7, v1
    v_lshrrev_b32 v5, 4, v1
    v_xor_b32 v3, v3, v5
    v_lshlrev_b32 v3, 4, v3
    v_xor_b32 v5, 64, v3
    v_add_u32 v12, v2, v3
    v_add_u32 v2, s34, v2
    v_add_u32 v13, v2, v5
    v_add_u32 v2, s34, v2
    v_add_u32 v14, v2, v3
    v_add_u32 v2, s34, v2
    v_add_u32 v15, v2, v5
    s_lshl_b32 s38, s31, 4
    s_add_u32 s38, s38, s56
    s_mul_i32 s38, s38, 81920
    s_mov_b32 s72, 0
    s_mov_b32 s39, 128
    s_mov_b32 s18, 2621440
    s_waitcnt lgkmcnt(0)
    s_mov_b32 s16, s4
    s_mov_b32 s17, s5
    s_branch L_BL
L_BW:
    v_lshrrev_b32 v2, 4, v1
    v_lshlrev_b32 v3, 2, v2
    v_and_b32 v5, 15, v1
    v_xor_b32 v3, v3, v5
    v_mul_u32_u24 v2, 3840, v2
    v_lshl_add_u32 v12, v3, 4, v2
    v_add_u32 v13, 14336, v12
    v_add_u32 v14, 28672, v12
    v_add_u32 v15, 43008, v12
    s_and_b32 s32, s30, 1
    s_mul_i32 s38, s32, 122880
    s_lshl_b32 s33, s57, 8
    s_add_u32 s38, s38, s33
    s_lshl_b32 s72, s32, 13
    s_add_u32 s72, s72, 8192
    s_mov_b32 s39, 245760
    s_mov_b32 s41, 61440
    s_mov_b32 s18, 2457600
    s_waitcnt lgkmcnt(0)
    s_mov_b32 s16, s6
    s_mov_b32 s17, s7
L_BL:
    s_mov_b32 s19, 0x00020000
    s_mov_b32 s43, 0
    s_cmp_ge_u32 s57, 15
    s_cbranch_scc1 L_Bsp
    s_cmp_eq_u32 s30, 5
    s_cbranch_scc1 L_B5
    s_branch L_lgo
L_lsub:
    s_mul_i32 s32, s37, s39
    s_add_u32 s32, s32, s38
    s_add_u32 m0, s43, s72
    s_add_u32 s37, s37, 1
    s_cmp_eq_u32 s37, 10
    s_cselect_b32 s37, 0, s37
    buffer_load_dwordx4 v12, s[16:19], s32 offen offset:0 lds
    buffer_load_dwordx4 v13, s[16:19], s32 offen offset:1024 lds
    buffer_load_dwordx4 v14, s[16:19], s32 offen offset:2048 lds
    buffer_load_dwordx4 v15, s[16:19], s32 offen offset:3072 lds
    s_add_u32 m0, m0, 4096
    s_add_u32 s32, s32, s41
    buffer_load_dwordx4 v12, s[16:19], s32 offen offset:0 lds
    buffer_load_dwordx4 v13, s[16:19], s32 offen offset:1024 lds
    buffer_load_dwordx4 v14, s[16:19], s32 offen offset:2048 lds
    buffer_load_dwordx4 v15, s[16:19], s32 offen offset:3072 lds
    s_setpc_b64 s[52:53]
L_lgo:
    s_mov_b32 s43, 131072
    s_call_b64 s[52:53], L_lsub
    s_mov_b32 s43, 0
    s_call_b64 s[52:53], L_lsub
    s_add_u32 s54, s8, 32505856
    s_addc_u32 s55, s9, 0
    s_load_dword s36, s[54:55], 0
    s_mov_b32 s20, s8
    s_mov_b32 s21, s9
    s_mov_b32 s22, 33554432
    s_mov_b32 s23, 0x00020000
    s_call_b64 s[52:53], L_bset
    s_call_b64 s[52:53], L_bse2
    s_waitcnt vmcnt(8)
    s_barrier
    s_mov_b32 s43, 24576
    s_call_b64 s[52:53], L_lsub
    s_mov_b32 s43, 49152
    s_call_b64 s[52:53], L_lsub
    s_waitcnt vmcnt(16)
    s_barrier
    s_mov_b32 s43, 81920
    s_call_b64 s[52:53], L_lsub
    s_waitcnt vmcnt(16)
    s_barrier
    s_mov_b32 s43, 106496
    s_call_b64 s[52:53], L_lsub
    s_waitcnt vmcnt(16)
    s_barrier
    s_mov_b32 s43, 131072
    s_call_b64 s[52:53], L_lsub
    s_waitcnt vmcnt(16)
    s_barrier
    s_mov_b32 s43, 0
    s_call_b64 s[52:53], L_lsub
    s_waitcnt vmcnt(16)
    s_barrier
    s_mov_b32 s43, 24576
    s_call_b64 s[52:53], L_lsub
    s_waitcnt vmcnt(16)
    s_barrier
    s_mov_b32 s43, 49152
    s_call_b64 s[52:53], L_lsub
    s_waitcnt vmcnt(16)
    s_barrier
    s_waitcnt vmcnt(8)
    s_barrier
    s_waitcnt vmcnt(0)
    s_barrier
    s_mov_b64 exec, -1
    s_barrier
    s_barrier
    s_branch L_Bs
L_Bsp:
    s_add_u32 s54, s8, 32505856
    s_addc_u32 s55, s9, 0
    s_load_dword s36, s[54:55], 0
    s_mov_b32 s20, s8
    s_mov_b32 s21, s9
    s_mov_b32 s22, 33554432
    s_mov_b32 s23, 0x00020000
    s_call_b64 s[52:53], L_bset
    s_call_b64 s[52:53], L_bse2
    s_branch L_Bs
L_B5:
    s_lshl_b32 s62, s56, 10
    s_add_u32 s62, s62, 32571392
    s_add_u32 s61, s62, 16384
    s_mov_b32 s42, 0
    s_add_u32 s54, s8, 32505856
    s_addc_u32 s55, s9, 0
    s_load_dword s36, s[54:55], 0
    s_mov_b32 s20, s8
    s_mov_b32 s21, s9
    s_mov_b32 s22, 33554432
    s_mov_b32 s23, 0x00020000
    s_call_b64 s[52:53], L_bset
    s_call_b64 s[52:53], L_bse2
    s_barrier
    s_barrier
    s_barrier
    s_barrier
    s_barrier
    s_barrier
    buffer_load_dwordx4 v[16:19], v6, s[20:23], s62 offen sc1
    buffer_load_dwordx4 v[20:23], v6, s[20:23], s61 offen sc1
    s_barrier
    s_barrier
    s_mov_b32 s43, 81920
    s_call_b64 s[52:53], L_lsub
    s_barrier
    s_mov_b32 s43, 90112
    s_call_b64 s[52:53], L_lsub
    s_mov_b32 s43, 98304
    s_call_b64 s[52:53], L_lsub
    s_waitcnt vmcnt(24) lgkmcnt(0)
    s_mul_i32 s33, s36, 0x9e3779b1
    s_add_u32 s33, s33, 0x7f4a7c15
    s_branch L_gc
L_gs:
    buffer_load_dwordx4 v[16:19], v6, s[20:23], s62 offen sc1
    buffer_load_dwordx4 v[20:23], v6, s[20:23], s61 offen sc1
    s_waitcnt vmcnt(0)
L_gc:
    v_xor_b32 v2, s33, v17
    v_xor_b32 v3, s33, v19
    v_xor_b32 v4, s33, v21
    v_xor_b32 v5, s33, v23
    v_or3_b32 v2, v2, v3, v4
    v_or_b32 v2, v2, v5
    s_add_u32 s42, s42, 1
    s_cmp_gt_u32 s42, 0x100000
    s_cbranch_scc1 L_gx
    v_cmp_eq_u32 vcc, 0, v2
    s_cmp_eq_u64 vcc, exec
    s_cbranch_scc0 L_gs
L_gx:
    v_lshlrev_b32 v3, 2, v1
    v_add_u32 v3, 73728, v3
    ds_write_b32 v3, v16 offset:0
    ds_write_b32 v3, v18 offset:256
    ds_write_b32 v3, v20 offset:512
    ds_write_b32 v3, v22 offset:768
    s_waitcnt lgkmcnt(0)
    s_barrier
    s_mov_b32 s43, 106496
    s_call_b64 s[52:53], L_lsub
    s_mov_b32 s43, 114688
    s_call_b64 s[52:53], L_lsub
    s_mov_b32 s43, 122880
    s_call_b64 s[52:53], L_lsub
    s_waitcnt vmcnt(16)
    s_mov_b32 s43, 131072
    s_call_b64 s[52:53], L_lsub
    s_mov_b32 s43, 139264
    s_call_b64 s[52:53], L_lsub
    s_barrier
    s_mov_b32 s43, 147456
    s_call_b64 s[52:53], L_lsub
    s_mov_b32 s43, 155648
    s_call_b64 s[52:53], L_lsub
    s_waitcnt vmcnt(0)
    s_barrier
L_Bs:
    s_waitcnt lgkmcnt(0)
    s_mul_i32 s36, s36, 0x9e3779b1
    s_add_u32 s36, s36, 0x7f4a7c15
    s_branch L_B2
L_A1:
    v_lshrrev_b32 v3, 5, v1
    v_and_b32 v2, 31, v1
    v_mul_u32_u24 v5, 1280, v3
    v_lshl_add_u32 v5, v2, 3, v5
    s_lshl_b32 s34, s63, 8
    s_lshl_b32 s32, s28, 3
    s_add_u32 s34, s34, s32
    s_lshl_b32 s32, s31, 1
    s_add_u32 s34, s34, s32
    s_mul_i32 s32, s34, 1280
    s_waitcnt lgkmcnt(0)
    s_mov_b32 s12, s4
    s_mov_b32 s13, s5
    s_mov_b32 s14, 2621440
    s_mov_b32 s15, 0x00020000
    buffer_load_dwordx2 v[232:233], v5, s[12:15], s32 offen offset:0
    buffer_load_dwordx2 v[234:235], v5, s[12:15], s32 offen offset:256
    buffer_load_dwordx2 v[236:237], v5, s[12:15], s32 offen offset:512
    buffer_load_dwordx2 v[238:239], v5, s[12:15], s32 offen offset:768
    buffer_load_dwordx2 v[240:241], v5, s[12:15], s32 offen offset:1024
    s_add_u32 s54, s8, 32505856
    s_addc_u32 s55, s9, 0
    s_load_dword s36, s[54:55], 0
    s_mov_b32 s20, s8
    s_mov_b32 s21, s9
    s_mov_b32 s22, 33554432
    s_mov_b32 s23, 0x00020000
    v_bfe_u32 v4, v1, 1, 3
    v_xor_b32 v4, v4, v3
    v_lshlrev_b32 v5, 7, v2
    v_add_u32 v5, 81920, v5
    v_xor_b32 v80, 0, v4
    v_lshl_add_u32 v80, v80, 4, v5
    v_xor_b32 v81, 2, v4
    v_lshl_add_u32 v81, v81, 4, v5
    v_xor_b32 v82, 4, v4
    v_lshl_add_u32 v82, v82, 4, v5
    v_xor_b32 v83, 6, v4
    v_lshl_add_u32 v83, v83, 4, v5
    v_bfe_u32 v4, v1, 2, 2
    v_lshl_add_u32 v5, v3, 3, v4
    v_lshlrev_b32 v5, 8, v5
    v_bfe_u32 v84, v1, 4, 1
    v_lshl_add_u32 v5, v84, 5, v5
    v_and_b32 v84, 3, v1
    v_lshl_add_u32 v5, v84, 3, v5
    v_add_u32 v5, 90112, v5
    v_xor_b32 v4, s31, v4
    v_lshl_add_u32 v84, v4, 6, v5
    s_lshl_b32 s62, s31, 7
    s_add_u32 s62, s62, 74752
    v_lshl_add_u32 v85, v2, 2, s62
    v_lshl_add_u32 v87, v3, 4, s62
    v_mov_b32 v88, 0x3f803f80
    v_mov_b32 v89, 0x3f803f80
    s_mov_b32 s69, s57
    s_mov_b32 s68, 0xffff0000
    s_cmp_ge_u32 s57, 5
    s_cselect_b32 s58, 1, 0
    s_cmp_ge_u32 s57, 10
    s_cselect_b32 s58, 2, s58
    s_mul_i32 s61, s58, 5
    s_sub_u32 s57, s57, s61
    s_mul_i32 s38, s58, 0x280000
    s_lshr_b32 s61, s56, 2
    s_mul_i32 s61, s61, 327680
    s_add_u32 s38, s38, s61
    s_and_b32 s32, s56, 3
    s_lshl_b32 s33, s57, 2
    s_add_u32 s33, s33, s31
    s_lshl_b32 s51, s69, 9
    s_lshl_b32 s61, s31, 7
    s_add_u32 s51, s51, s61
    s_lshl_b32 s61, s56, 2
    s_add_u32 s51, s51, s61
    s_lshl_b32 s51, s51, 5
    s_add_u32 s51, s51, 32636928
    s_cmp_eq_u32 s58, 2
    s_cbranch_scc1 L_sv
    v_lshlrev_b32 v86, 3, v2
    v_add_u32 v86, 73728, v86
    v_lshlrev_b32 v95, 11, v3
    v_lshl_add_u32 v95, v2, 4, v95
    s_lshl_b32 s61, s33, 14
    s_add_u32 s38, s38, s61
    s_lshl_b32 s61, s32, 9
    s_add_u32 s64, s38, s61
    s_add_u32 s65, s64, 4096
    s_add_u32 s66, s65, 4096
    s_add_u32 s67, s66, 4096
    s_cmp_eq_u32 s58, 0
    s_cselect_b32 s61, 0x3ea52b5c, 1.0
    s_branch L_sd
L_sv:
    v_lshlrev_b32 v86, 4, v3
    v_add_u32 v86, 73728, v86
    v_mul_u32_u24 v95, 10240, v3
    v_lshl_add_u32 v95, v2, 4, v95
    s_lshl_b32 s61, s33, 9
    s_add_u32 s38, s38, s61
    s_mul_i32 s61, s32, 81920
    s_add_u32 s64, s38, s61
    s_add_u32 s65, s64, 20480
    s_add_u32 s66, s65, 20480
    s_add_u32 s67, s66, 20480
L_sd:
    v_mov_b32 v9, v7
    v_and_b32 v2, 31, v1
    v_lshrrev_b32 v3, 5, v1
    v_lshlrev_b32 v8, 12, v3
    v_lshl_add_u32 v8, v2, 3, v8
    v_add_u32 v11, 256, v8
    v_mul_u32_u24 v3, 20, v3
    v_add_u32 v2, v2, v3
    v_lshlrev_b32 v10, 4, v2
    s_mov_b32 s44, 0x000fffff
    s_mov_b32 s45, 0x000fffff
    s_cmp_ge_u32 s69, 15
    s_cbranch_scc1 L_A2
    s_waitcnt lgkmcnt(0)
    s_barrier
    ds_read_b128 v[44:47], v80 offset:49152
    ds_read_b128 v[48:51], v80 offset:53248
    ds_read_b64_tr_b16 v[96:97], v84 offset:49152
    ds_read_b64_tr_b16 v[98:99], v84 offset:50176
    ds_read_b128 v[52:55], v81 offset:49152
    ds_read_b128 v[56:59], v81 offset:53248
    ds_read_b64_tr_b16 v[100:101], v84 offset:53248
    ds_read_b64_tr_b16 v[102:103], v84 offset:54272
    s_cmp_eq_u32 s58, 2
    s_cbranch_scc1 L_aV
L_aQ:
    s_waitcnt lgkmcnt(4)
    v_mfma_f32_32x32x16_bf16 v[12:27], v[96:99], v[44:47], 0
    ds_read_b128 v[60:63], v82 offset:49152
    ds_read_b128 v[64:67], v82 offset:53248
    v_mfma_f32_32x32x16_bf16 v[28:43], v[96:99], v[48:51], 0
    ds_read_b64_tr_b16 v[104:105], v84 offset:57344
    ds_read_b64_tr_b16 v[106:107], v84 offset:58368
    s_waitcnt lgkmcnt(4)
    v_mfma_f32_32x32x16_bf16 v[12:27], v[100:103], v[52:55], v[12:27]
    ds_read_b128 v[68:71], v83 offset:49152
    ds_read_b128 v[72:75], v83 offset:53248
    v_mfma_f32_32x32x16_bf16 v[28:43], v[100:103], v[56:59], v[28:43]
    ds_read_b64_tr_b16 v[108:109], v84 offset:61440
    ds_read_b64_tr_b16 v[110:111], v84 offset:62464
    s_call_b64 s[52:53], L_sx
    v_mfma_f32_4x4x4_16b_bf16 v[76:79], v[88:89], v[96:97], 0
    v_mfma_f32_4x4x4_16b_bf16 v[90:93], v[88:89], v[98:99], 0
    s_nop 0
    v_mfma_f32_4x4x4_16b_bf16 v[76:79], v[88:89], v[100:101], v[76:79]
    v_mfma_f32_4x4x4_16b_bf16 v[90:93], v[88:89], v[102:103], v[90:93]
    s_nop 0
    s_waitcnt lgkmcnt(4)
    v_mfma_f32_32x32x16_bf16 v[12:27], v[104:107], v[60:63], v[12:27]
    s_barrier
    v_subrev_u32 v80, 81920, v80
    v_subrev_u32 v84, 81920, v84
    ds_read_b128 v[44:47], v80 offset:0
    ds_read_b128 v[48:51], v80 offset:4096
    v_mfma_f32_32x32x16_bf16 v[28:43], v[104:107], v[64:67], v[28:43]
    ds_read_b64_tr_b16 v[112:113], v84 offset:0
    ds_read_b64_tr_b16 v[114:115], v84 offset:1024
    s_waitcnt lgkmcnt(4)
    v_mfma_f32_32x32x16_bf16 v[12:27], v[108:111], v[68:71], v[12:27]
    v_subrev_u32 v81, 81920, v81
    ds_read_b128 v[52:55], v81 offset:0
    ds_read_b128 v[56:59], v81 offset:4096
    v_mfma_f32_32x32x16_bf16 v[28:43], v[108:111], v[72:75], v[28:43]
    ds_read_b64_tr_b16 v[116:117], v84 offset:4096
    ds_read_b64_tr_b16 v[118:119], v84 offset:5120
    s_waitcnt lgkmcnt(4)
    v_mfma_f32_32x32x16_bf16 v[12:27], v[112:115], v[44:47], v[12:27]
    v_subrev_u32 v82, 81920, v82
    ds_read_b128 v[60:63], v82 offset:0
    ds_read_b128 v[64:67], v82 offset:4096
    v_mfma_f32_32x32x16_bf16 v[28:43], v[112:115], v[48:51], v[28:43]
    ds_read_b64_tr_b16 v[120:121], v84 offset:8192
    ds_read_b64_tr_b16 v[122:123], v84 offset:9216
    s_waitcnt lgkmcnt(4)
    v_mfma_f32_32x32x16_bf16 v[12:27], v[116:119], v[52:55], v[12:27]
    v_subrev_u32 v83, 81920, v83
    ds_read_b128 v[68:71], v83 offset:0
    ds_read_b128 v[72:75], v83 offset:4096
    v_mfma_f32_32x32x16_bf16 v[28:43], v[116:119], v[56:59], v[28:43]
    ds_read_b64_tr_b16 v[124:125], v84 offset:12288
    ds_read_b64_tr_b16 v[126:127], v84 offset:13312
    v_mfma_f32_4x4x4_16b_bf16 v[76:79], v[88:89], v[104:105], v[76:79]
    v_mfma_f32_4x4x4_16b_bf16 v[90:93], v[88:89], v[106:107], v[90:93]
    s_nop 0
    v_mfma_f32_4x4x4_16b_bf16 v[76:79], v[88:89], v[108:109], v[76:79]
    v_mfma_f32_4x4x4_16b_bf16 v[90:93], v[88:89], v[110:111], v[90:93]
    s_nop 0
    v_mfma_f32_4x4x4_16b_bf16 v[76:79], v[88:89], v[112:113], v[76:79]
    v_mfma_f32_4x4x4_16b_bf16 v[90:93], v[88:89], v[114:115], v[90:93]
    s_nop 0
    v_mfma_f32_4x4x4_16b_bf16 v[76:79], v[88:89], v[116:117], v[76:79]
    v_mfma_f32_4x4x4_16b_bf16 v[90:93], v[88:89], v[118:119], v[90:93]
    s_nop 0
    s_waitcnt lgkmcnt(4)
    v_mfma_f32_32x32x16_bf16 v[12:27], v[120:123], v[60:63], v[12:27]
    s_barrier
    ds_read_b128 v[44:47], v80 offset:24576
    ds_read_b128 v[48:51], v80 offset:28672
    v_mfma_f32_32x32x16_bf16 v[28:43], v[120:123], v[64:67], v[28:43]
    ds_read_b64_tr_b16 v[128:129], v84 offset:24576
    ds_read_b64_tr_b16 v[130:131], v84 offset:25600
    s_waitcnt lgkmcnt(4)
    v_mfma_f32_32x32x16_bf16 v[12:27], v[124:127], v[68:71], v[12:27]
    ds_read_b128 v[52:55], v81 offset:24576
    ds_read_b128 v[56:59], v81 offset:28672
    v_mfma_f32_32x32x16_bf16 v[28:43], v[124:127], v[72:75], v[28:43]
    ds_read_b64_tr_b16 v[132:133], v84 offset:28672
    ds_read_b64_tr_b16 v[134:135], v84 offset:29696
    s_waitcnt lgkmcnt(4)
    v_mfma_f32_32x32x16_bf16 v[12:27], v[128:131], v[44:47], v[12:27]
    ds_read_b128 v[60:63], v82 offset:24576
    ds_read_b128 v[64:67], v82 offset:28672
    v_mfma_f32_32x32x16_bf16 v[28:43], v[128:131], v[48:51], v[28:43]
    ds_read_b64_tr_b16 v[136:137], v84 offset:32768
    ds_read_b64_tr_b16 v[138:139], v84 offset:33792
    s_waitcnt lgkmcnt(4)
    v_mfma_f32_32x32x16_bf16 v[12:27], v[132:135], v[52:55], v[12:27]
    ds_read_b128 v[68:71], v83 offset:24576
    ds_read_b128 v[72:75], v83 offset:28672
    v_mfma_f32_32x32x16_bf16 v[28:43], v[132:135], v[56:59], v[28:43]
    ds_read_b64_tr_b16 v[140:141], v84 offset:36864
    ds_read_b64_tr_b16 v[142:143], v84 offset:37888
    v_mfma_f32_4x4x4_16b_bf16 v[76:79], v[88:89], v[120:121], v[76:79]
    v_mfma_f32_4x4x4_16b_bf16 v[90:93], v[88:89], v[122:123], v[90:93]
    s_nop 0
    v_mfma_f32_4x4x4_16b_bf16 v[76:79], v[88:89], v[124:125], v[76:79]
    v_mfma_f32_4x4x4_16b_bf16 v[90:93], v[88:89], v[126:127], v[90:93]
    s_nop 0
    v_mfma_f32_4x4x4_16b_bf16 v[76:79], v[88:89], v[128:129], v[76:79]
    v_mfma_f32_4x4x4_16b_bf16 v[90:93], v[88:89], v[130:131], v[90:93]
    s_nop 0
    v_mfma_f32_4x4x4_16b_bf16 v[76:79], v[88:89], v[132:133], v[76:79]
    v_mfma_f32_4x4x4_16b_bf16 v[90:93], v[88:89], v[134:135], v[90:93]
    s_nop 0
    s_waitcnt lgkmcnt(4)
    v_mfma_f32_32x32x16_bf16 v[12:27], v[136:139], v[60:63], v[12:27]
    s_barrier
    ds_read_b128 v[44:47], v80 offset:49152
    ds_read_b128 v[48:51], v80 offset:53248
    v_mfma_f32_32x32x16_bf16 v[28:43], v[136:139], v[64:67], v[28:43]
    ds_read_b64_tr_b16 v[144:145], v84 offset:49152
    ds_read_b64_tr_b16 v[146:147], v84 offset:50176
    s_waitcnt lgkmcnt(4)
    v_mfma_f32_32x32x16_bf16 v[12:27], v[140:143], v[68:71], v[12:27]
    ds_read_b128 v[52:55], v81 offset:49152
    ds_read_b128 v[56:59], v81 offset:53248
    v_mfma_f32_32x32x16_bf16 v[28:43], v[140:143], v[72:75], v[28:43]
    ds_read_b64_tr_b16 v[148:149], v84 offset:53248
    ds_read_b64_tr_b16 v[150:151], v84 offset:54272
    s_waitcnt lgkmcnt(4)
    v_mfma_f32_32x32x16_bf16 v[12:27], v[144:147], v[44:47], v[12:27]
    ds_read_b128 v[60:63], v82 offset:49152
    ds_read_b128 v[64:67], v82 offset:53248
    v_mfma_f32_32x32x16_bf16 v[28:43], v[144:147], v[48:51], v[28:43]
    ds_read_b64_tr_b16 v[152:153], v84 offset:57344
    ds_read_b64_tr_b16 v[154:155], v84 offset:58368
    s_waitcnt lgkmcnt(4)
    v_mfma_f32_32x32x16_bf16 v[12:27], v[148:151], v[52:55], v[12:27]
    ds_read_b128 v[68:71], v83 offset:49152
    ds_read_b128 v[72:75], v83 offset:53248
    v_mfma_f32_32x32x16_bf16 v[28:43], v[148:151], v[56:59], v[28:43]
    ds_read_b64_tr_b16 v[156:157], v84 offset:61440
    ds_read_b64_tr_b16 v[158:159], v84 offset:62464
    v_mfma_f32_4x4x4_16b_bf16 v[76:79], v[88:89], v[136:137], v[76:79]
    v_mfma_f32_4x4x4_16b_bf16 v[90:93], v[88:89], v[138:139], v[90:93]
    s_nop 0
    v_mfma_f32_4x4x4_16b_bf16 v[76:79], v[88:89], v[140:141], v[76:79]
    v_mfma_f32_4x4x4_16b_bf16 v[90:93], v[88:89], v[142:143], v[90:93]
    s_nop 0
    v_mfma_f32_4x4x4_16b_bf16 v[76:79], v[88:89], v[144:145], v[76:79]
    v_mfma_f32_4x4x4_16b_bf16 v[90:93], v[88:89], v[146:147], v[90:93]
    s_nop 0
    v_mfma_f32_4x4x4_16b_bf16 v[76:79], v[88:89], v[148:149], v[76:79]
    v_mfma_f32_4x4x4_16b_bf16 v[90:93], v[88:89], v[150:151], v[90:93]
    s_nop 0
    s_waitcnt lgkmcnt(4)
    v_mfma_f32_32x32x16_bf16 v[12:27], v[152:155], v[60:63], v[12:27]
    s_barrier
    v_add_u32 v80, 81920, v80
    v_add_u32 v84, 81920, v84
    ds_read_b128 v[44:47], v80 offset:0
    ds_read_b128 v[48:51], v80 offset:4096
    v_mfma_f32_32x32x16_bf16 v[28:43], v[152:155], v[64:67], v[28:43]
    ds_read_b64_tr_b16 v[160:161], v84 offset:0
    ds_read_b64_tr_b16 v[162:163], v84 offset:1024
    s_waitcnt lgkmcnt(4)
    v_mfma_f32_32x32x16_bf16 v[12:27], v[156:159], v[68:71], v[12:27]
    v_add_u32 v81, 81920, v81
    ds_read_b128 v[52:55], v81 offset:0
    ds_read_b128 v[56:59], v81 offset:4096
    v_mfma_f32_32x32x16_bf16 v[28:43], v[156:159], v[72:75], v[28:43]
    ds_read_b64_tr_b16 v[164:165], v84 offset:4096
    ds_read_b64_tr_b16 v[166:167], v84 offset:5120
    s_waitcnt lgkmcnt(4)
    v_mfma_f32_32x32x16_bf16 v[12:27], v[160:163], v[44:47], v[12:27]
    v_add_u32 v82, 81920, v82
    ds_read_b128 v[60:63], v82 offset:0
    ds_read_b128 v[64:67], v82 offset:4096
    v_mfma_f32_32x32x16_bf16 v[28:43], v[160:163], v[48:51], v[28:43]
    ds_read_b64_tr_b16 v[168:169], v84 offset:8192
    ds_read_b64_tr_b16 v[170:171], v84 offset:9216
    s_waitcnt lgkmcnt(4)
    v_mfma_f32_32x32x16_bf16 v[12:27], v[164:167], v[52:55], v[12:27]
    v_add_u32 v83, 81920, v83
    ds_read_b128 v[68:71], v83 offset:0
    ds_read_b128 v[72:75], v83 offset:4096
    v_mfma_f32_32x32x16_bf16 v[28:43], v[164:167], v[56:59], v[28:43]
    ds_read_b64_tr_b16 v[172:173], v84 offset:12288
    ds_read_b64_tr_b16 v[174:175], v84 offset:13312
    v_mfma_f32_4x4x4_16b_bf16 v[76:79], v[88:89], v[152:153], v[76:79]
    v_mfma_f32_4x4x4_16b_bf16 v[90:93], v[88:89], v[154:155], v[90:93]
    s_nop 0
    v_mfma_f32_4x4x4_16b_bf16 v[76:79], v[88:89], v[156:157], v[76:79]
    v_mfma_f32_4x4x4_16b_bf16 v[90:93], v[88:89], v[158:159], v[90:93]
    s_nop 0
    v_mfma_f32_4x4x4_16b_bf16 v[76:79], v[88:89], v[160:161], v[76:79]
    v_mfma_f32_4x4x4_16b_bf16 v[90:93], v[88:89], v[162:163], v[90:93]
    s_nop 0
    v_mfma_f32_4x4x4_16b_bf16 v[76:79], v[88:89], v[164:165], v[76:79]
    v_mfma_f32_4x4x4_16b_bf16 v[90:93], v[88:89], v[166:167], v[90:93]
    s_nop 0
    s_waitcnt lgkmcnt(4)
    v_mfma_f32_32x32x16_bf16 v[12:27], v[168:171], v[60:63], v[12:27]
    s_barrier
    ds_read_b128 v[44:47], v80 offset:24576
    ds_read_b128 v[48:51], v80 offset:28672
    v_mfma_f32_32x32x16_bf16 v[28:43], v[168:171], v[64:67], v[28:43]
    ds_read_b64_tr_b16 v[176:177], v84 offset:24576
    ds_read_b64_tr_b16 v[178:179], v84 offset:25600
    s_waitcnt lgkmcnt(4)
    v_mfma_f32_32x32x16_bf16 v[12:27], v[172:175], v[68:71], v[12:27]
    ds_read_b128 v[52:55], v81 offset:24576
    ds_read_b128 v[56:59], v81 offset:28672
    v_mfma_f32_32x32x16_bf16 v[28:43], v[172:175], v[72:75], v[28:43]
    ds_read_b64_tr_b16 v[180:181], v84 offset:28672
    ds_read_b64_tr_b16 v[182:183], v84 offset:29696
    s_waitcnt lgkmcnt(4)
    v_mfma_f32_32x32x16_bf16 v[12:27], v[176:179], v[44:47], v[12:27]
    ds_read_b128 v[60:63], v82 offset:24576
    ds_read_b128 v[64:67], v82 offset:28672
    v_mfma_f32_32x32x16_bf16 v[28:43], v[176:179], v[48:51], v[28:43]
    ds_read_b64_tr_b16 v[184:185], v84 offset:32768
    ds_read_b64_tr_b16 v[186:187], v84 offset:33792
    s_waitcnt lgkmcnt(4)
    v_mfma_f32_32x32x16_bf16 v[12:27], v[180:183], v[52:55], v[12:27]
    ds_read_b128 v[68:71], v83 offset:24576
    ds_read_b128 v[72:75], v83 offset:28672
    v_mfma_f32_32x32x16_bf16 v[28:43], v[180:183], v[56:59], v[28:43]
    ds_read_b64_tr_b16 v[188:189], v84 offset:36864
    ds_read_b64_tr_b16 v[190:191], v84 offset:37888
    v_mfma_f32_4x4x4_16b_bf16 v[76:79], v[88:89], v[168:169], v[76:79]
    v_mfma_f32_4x4x4_16b_bf16 v[90:93], v[88:89], v[170:171], v[90:93]
    s_nop 0
    v_mfma_f32_4x4x4_16b_bf16 v[76:79], v[88:89], v[172:173], v[76:79]
    v_mfma_f32_4x4x4_16b_bf16 v[90:93], v[88:89], v[174:175], v[90:93]
    s_nop 0
    v_mfma_f32_4x4x4_16b_bf16 v[76:79], v[88:89], v[176:177], v[76:79]
    v_mfma_f32_4x4x4_16b_bf16 v[90:93], v[88:89], v[178:179], v[90:93]
    s_nop 0
    v_mfma_f32_4x4x4_16b_bf16 v[76:79], v[88:89], v[180:181], v[76:79]
    v_mfma_f32_4x4x4_16b_bf16 v[90:93], v[88:89], v[182:183], v[90:93]
    s_nop 0
    s_waitcnt lgkmcnt(4)
    v_mfma_f32_32x32x16_bf16 v[12:27], v[184:187], v[60:63], v[12:27]
    s_barrier
    ds_read_b128 v[44:47], v80 offset:49152
    ds_read_b128 v[48:51], v80 offset:53248
    v_mfma_f32_32x32x16_bf16 v[28:43], v[184:187], v[64:67], v[28:43]
    ds_read_b64_tr_b16 v[192:193], v84 offset:49152
    ds_read_b64_tr_b16 v[194:195], v84 offset:50176
    s_waitcnt lgkmcnt(4)
    v_mfma_f32_32x32x16_bf16 v[12:27], v[188:191], v[68:71], v[12:27]
    ds_read_b128 v[52:55], v81 offset:49152
    ds_read_b128 v[56:59], v81 offset:53248
    v_mfma_f32_32x32x16_bf16 v[28:43], v[188:191], v[72:75], v[28:43]
    ds_read_b64_tr_b16 v[196:197], v84 offset:53248
    ds_read_b64_tr_b16 v[198:199], v84 offset:54272
    s_waitcnt lgkmcnt(4)
    v_mfma_f32_32x32x16_bf16 v[12:27], v[192:195], v[44:47], v[12:27]
    ds_read_b128 v[60:63], v82 offset:49152
    ds_read_b128 v[64:67], v82 offset:53248
    v_mfma_f32_32x32x16_bf16 v[28:43], v[192:195], v[48:51], v[28:43]
    ds_read_b64_tr_b16 v[200:201], v84 offset:57344
    ds_read_b64_tr_b16 v[202:203], v84 offset:58368
    s_waitcnt lgkmcnt(4)
    v_mfma_f32_32x32x16_bf16 v[12:27], v[196:199], v[52:55], v[12:27]
    ds_read_b128 v[68:71], v83 offset:49152
    ds_read_b128 v[72:75], v83 offset:53248
    v_mfma_f32_32x32x16_bf16 v[28:43], v[196:199], v[56:59], v[28:43]
    ds_read_b64_tr_b16 v[204:205], v84 offset:61440
    ds_read_b64_tr_b16 v[206:207], v84 offset:62464
    v_mfma_f32_4x4x4_16b_bf16 v[76:79], v[88:89], v[184:185], v[76:79]
    v_mfma_f32_4x4x4_16b_bf16 v[90:93], v[88:89], v[186:187], v[90:93]
    s_nop 0
    v_mfma_f32_4x4x4_16b_bf16 v[76:79], v[88:89], v[188:189], v[76:79]
    v_mfma_f32_4x4x4_16b_bf16 v[90:93], v[88:89], v[190:191], v[90:93]
    s_nop 0
    v_mfma_f32_4x4x4_16b_bf16 v[76:79], v[88:89], v[192:193], v[76:79]
    v_mfma_f32_4x4x4_16b_bf16 v[90:93], v[88:89], v[194:195], v[90:93]
    s_nop 0
    v_mfma_f32_4x4x4_16b_bf16 v[76:79], v[88:89], v[196:197], v[76:79]
    v_mfma_f32_4x4x4_16b_bf16 v[90:93], v[88:89], v[198:199], v[90:93]
    s_nop 0
    s_waitcnt lgkmcnt(4)
    v_mfma_f32_32x32x16_bf16 v[12:27], v[200:203], v[60:63], v[12:27]
    s_barrier
    v_subrev_u32 v80, 81920, v80
    v_subrev_u32 v84, 81920, v84
    ds_read_b128 v[44:47], v80 offset:0
    ds_read_b128 v[48:51], v80 offset:4096
    v_mfma_f32_32x32x16_bf16 v[28:43], v[200:203], v[64:67], v[28:43]
    ds_read_b64_tr_b16 v[208:209], v84 offset:0
    ds_read_b64_tr_b16 v[210:211], v84 offset:1024
    s_waitcnt lgkmcnt(4)
    v_mfma_f32_32x32x16_bf16 v[12:27], v[204:207], v[68:71], v[12:27]
    v_subrev_u32 v81, 81920, v81
    ds_read_b128 v[52:55], v81 offset:0
    ds_read_b128 v[56:59], v81 offset:4096
    v_mfma_f32_32x32x16_bf16 v[28:43], v[204:207], v[72:75], v[28:43]
    ds_read_b64_tr_b16 v[212:213], v84 offset:4096
    ds_read_b64_tr_b16 v[214:215], v84 offset:5120
    s_waitcnt lgkmcnt(4)
    v_mfma_f32_32x32x16_bf16 v[12:27], v[208:211], v[44:47], v[12:27]
    v_subrev_u32 v82, 81920, v82
    ds_read_b128 v[60:63], v82 offset:0
    ds_read_b128 v[64:67], v82 offset:4096
    v_mfma_f32_32x32x16_bf16 v[28:43], v[208:211], v[48:51], v[28:43]
    ds_read_b64_tr_b16 v[216:217], v84 offset:8192
    ds_read_b64_tr_b16 v[218:219], v84 offset:9216
    s_waitcnt lgkmcnt(4)
    v_mfma_f32_32x32x16_bf16 v[12:27], v[212:215], v[52:55], v[12:27]
    v_subrev_u32 v83, 81920, v83
    ds_read_b128 v[68:71], v83 offset:0
    ds_read_b128 v[72:75], v83 offset:4096
    v_mfma_f32_32x32x16_bf16 v[28:43], v[212:215], v[56:59], v[28:43]
    ds_read_b64_tr_b16 v[220:221], v84 offset:12288
    ds_read_b64_tr_b16 v[222:223], v84 offset:13312
    v_mfma_f32_4x4x4_16b_bf16 v[76:79], v[88:89], v[200:201], v[76:79]
    v_mfma_f32_4x4x4_16b_bf16 v[90:93], v[88:89], v[202:203], v[90:93]
    s_nop 0
    v_mfma_f32_4x4x4_16b_bf16 v[76:79], v[88:89], v[204:205], v[76:79]
    v_mfma_f32_4x4x4_16b_bf16 v[90:93], v[88:89], v[206:207], v[90:93]
    s_nop 0
    v_mfma_f32_4x4x4_16b_bf16 v[76:79], v[88:89], v[208:209], v[76:79]
    v_mfma_f32_4x4x4_16b_bf16 v[90:93], v[88:89], v[210:211], v[90:93]
    s_nop 0
    v_mfma_f32_4x4x4_16b_bf16 v[76:79], v[88:89], v[212:213], v[76:79]
    v_mfma_f32_4x4x4_16b_bf16 v[90:93], v[88:89], v[214:215], v[90:93]
    s_nop 0
    s_waitcnt lgkmcnt(4)
    v_mfma_f32_32x32x16_bf16 v[12:27], v[216:219], v[60:63], v[12:27]
    s_barrier
    ds_read_b128 v[44:47], v80 offset:24576
    ds_read_b128 v[48:51], v80 offset:28672
    v_mfma_f32_32x32x16_bf16 v[28:43], v[216:219], v[64:67], v[28:43]
    ds_read_b64_tr_b16 v[224:225], v84 offset:24576
    ds_read_b64_tr_b16 v[226:227], v84 offset:25600
    s_waitcnt lgkmcnt(4)
    v_mfma_f32_32x32x16_bf16 v[12:27], v[220:223], v[68:71], v[12:27]
    ds_read_b128 v[52:55], v81 offset:24576
    ds_read_b128 v[56:59], v81 offset:28672
    v_mfma_f32_32x32x16_bf16 v[28:43], v[220:223], v[72:75], v[28:43]
    ds_read_b64_tr_b16 v[228:229], v84 offset:28672
    ds_read_b64_tr_b16 v[230:231], v84 offset:29696
    s_waitcnt lgkmcnt(4)
    v_mfma_f32_32x32x16_bf16 v[12:27], v[224:227], v[44:47], v[12:27]
    ds_read_b128 v[60:63], v82 offset:24576
    ds_read_b128 v[64:67], v82 offset:28672
    v_mfma_f32_32x32x16_bf16 v[28:43], v[224:227], v[48:51], v[28:43]
    ds_read_b64_tr_b16 v[232:233], v84 offset:32768
    ds_read_b64_tr_b16 v[234:235], v84 offset:33792
    s_waitcnt lgkmcnt(4)
    v_mfma_f32_32x32x16_bf16 v[12:27], v[228:231], v[52:55], v[12:27]
    ds_read_b128 v[68:71], v83 offset:24576
    ds_read_b128 v[72:75], v83 offset:28672
    v_mfma_f32_32x32x16_bf16 v[28:43], v[228:231], v[56:59], v[28:43]
    ds_read_b64_tr_b16 v[236:237], v84 offset:36864
    ds_read_b64_tr_b16 v[238:239], v84 offset:37888
    v_mfma_f32_4x4x4_16b_bf16 v[76:79], v[88:89], v[216:217], v[76:79]
    v_mfma_f32_4x4x4_16b_bf16 v[90:93], v[88:89], v[218:219], v[90:93]
    s_nop 0
    v_mfma_f32_4x4x4_16b_bf16 v[76:79], v[88:89], v[220:221], v[76:79]
    v_mfma_f32_4x4x4_16b_bf16 v[90:93], v[88:89], v[222:223], v[90:93]
    s_nop 0
    v_mfma_f32_4x4x4_16b_bf16 v[76:79], v[88:89], v[224:225], v[76:79]
    v_mfma_f32_4x4x4_16b_bf16 v[90:93], v[88:89], v[226:227], v[90:93]
    s_nop 0
    v_mfma_f32_4x4x4_16b_bf16 v[76:79], v[88:89], v[228:229], v[76:79]
    v_mfma_f32_4x4x4_16b_bf16 v[90:93], v[88:89], v[230:231], v[90:93]
    s_nop 0
    s_waitcnt lgkmcnt(4)
    v_mfma_f32_32x32x16_bf16 v[12:27], v[232:235], v[60:63], v[12:27]
    s_barrier
    ds_read_b128 v[44:47], v80 offset:49152
    ds_read_b128 v[48:51], v80 offset:53248
    v_mfma_f32_32x32x16_bf16 v[28:43], v[232:235], v[64:67], v[28:43]
    ds_read_b64_tr_b16 v[240:241], v84 offset:49152
    ds_read_b64_tr_b16 v[242:243], v84 offset:50176
    s_waitcnt lgkmcnt(4)
    v_mfma_f32_32x32x16_bf16 v[12:27], v[236:239], v[68:71], v[12:27]
    ds_read_b128 v[52:55], v81 offset:49152
    ds_read_b128 v[56:59], v81 offset:53248
    v_mfma_f32_32x32x16_bf16 v[28:43], v[236:239], v[72:75], v[28:43]
    ds_read_b64_tr_b16 v[244:245], v84 offset:53248
    ds_read_b64_tr_b16 v[246:247], v84 offset:54272
    s_waitcnt lgkmcnt(4)
    v_mfma_f32_32x32x16_bf16 v[12:27], v[240:243], v[44:47], v[12:27]
    ds_read_b128 v[60:63], v82 offset:49152
    ds_read_b128 v[64:67], v82 offset:53248
    v_mfma_f32_32x32x16_bf16 v[28:43], v[240:243], v[48:51], v[28:43]
    ds_read_b64_tr_b16 v[248:249], v84 offset:57344
    ds_read_b64_tr_b16 v[250:251], v84 offset:58368
    s_waitcnt lgkmcnt(4)
    v_mfma_f32_32x32x16_bf16 v[12:27], v[244:247], v[52:55], v[12:27]
    ds_read_b128 v[68:71], v83 offset:49152
    ds_read_b128 v[72:75], v83 offset:53248
    v_mfma_f32_32x32x16_bf16 v[28:43], v[244:247], v[56:59], v[28:43]
    ds_read_b64_tr_b16 v[252:253], v84 offset:61440
    ds_read_b64_tr_b16 v[254:255], v84 offset:62464
    v_mfma_f32_4x4x4_16b_bf16 v[76:79], v[88:89], v[232:233], v[76:79]
    v_mfma_f32_4x4x4_16b_bf16 v[90:93], v[88:89], v[234:235], v[90:93]
    s_nop 0
    v_mfma_f32_4x4x4_16b_bf16 v[76:79], v[88:89], v[236:237], v[76:79]
    v_mfma_f32_4x4x4_16b_bf16 v[90:93], v[88:89], v[238:239], v[90:93]
    s_nop 0
    v_mfma_f32_4x4x4_16b_bf16 v[76:79], v[88:89], v[240:241], v[76:79]
    v_mfma_f32_4x4x4_16b_bf16 v[90:93], v[88:89], v[242:243], v[90:93]
    s_nop 0
    v_mfma_f32_4x4x4_16b_bf16 v[76:79], v[88:89], v[244:245], v[76:79]
    v_mfma_f32_4x4x4_16b_bf16 v[90:93], v[88:89], v[246:247], v[90:93]
    s_nop 0
    s_waitcnt lgkmcnt(4)
    v_mfma_f32_32x32x16_bf16 v[12:27], v[248:251], v[60:63], v[12:27]
    v_mfma_f32_32x32x16_bf16 v[28:43], v[248:251], v[64:67], v[28:43]
    s_waitcnt lgkmcnt(0)
    v_mfma_f32_4x4x4_16b_bf16 v[76:79], v[88:89], v[248:249], v[76:79]
    v_mfma_f32_4x4x4_16b_bf16 v[90:93], v[88:89], v[250:251], v[90:93]
    s_nop 0
    v_mfma_f32_4x4x4_16b_bf16 v[76:79], v[88:89], v[252:253], v[76:79]
    v_mfma_f32_4x4x4_16b_bf16 v[90:93], v[88:89], v[254:255], v[90:93]
    s_nop 0
    s_waitcnt lgkmcnt(0)
    v_mfma_f32_32x32x16_bf16 v[12:27], v[252:255], v[68:71], v[12:27]
    v_mfma_f32_32x32x16_bf16 v[28:43], v[252:255], v[72:75], v[28:43]
    s_nop 0
    v_add_f32 v76, v76, v90
    v_add_f32 v77, v77, v90
    v_add_u32 v80, 81920, v80
    v_add_u32 v81, 81920, v81
    v_add_u32 v82, 81920, v82
    v_add_u32 v83, 81920, v83
    v_permlane32_swap_b32 v76, v77
    v_add_f32 v76, v76, v77
    ds_write_b32 v85, v76
    s_call_b64 s[52:53], L_epQ
    s_barrier
    ds_read_b128 v[44:47], v80 offset:0
    ds_read_b128 v[48:51], v80 offset:4096
    ds_read_b128 v[52:55], v81 offset:0
    ds_read_b128 v[56:59], v81 offset:4096
    ds_read_b128 v[60:63], v82 offset:0
    ds_read_b128 v[64:67], v82 offset:4096
    s_waitcnt lgkmcnt(4)
    v_mfma_f32_32x32x16_bf16 v[12:27], v[96:99], v[44:47], 0
    ds_read_b128 v[68:71], v83 offset:0
    v_mfma_f32_32x32x16_bf16 v[28:43], v[96:99], v[48:51], 0
    ds_read_b128 v[72:75], v83 offset:4096
    s_waitcnt lgkmcnt(4)
    v_mfma_f32_32x32x16_bf16 v[12:27], v[100:103], v[52:55], v[12:27]
    ds_read_b128 v[44:47], v80 offset:8192
    v_mfma_f32_32x32x16_bf16 v[28:43], v[100:103], v[56:59], v[28:43]
    ds_read_b128 v[48:51], v80 offset:12288
    s_waitcnt lgkmcnt(4)
    v_mfma_f32_32x32x16_bf16 v[12:27], v[104:107], v[60:63], v[12:27]
    ds_read_b128 v[52:55], v81 offset:8192
    v_mfma_f32_32x32x16_bf16 v[28:43], v[104:107], v[64:67], v[28:43]
    ds_read_b128 v[56:59], v81 offset:12288
    s_waitcnt lgkmcnt(4)
    v_mfma_f32_32x32x16_bf16 v[12:27], v[108:111], v[68:71], v[12:27]
    ds_read_b128 v[60:63], v82 offset:8192
    v_mfma_f32_32x32x16_bf16 v[28:43], v[108:111], v[72:75], v[28:43]
    ds_read_b128 v[64:67], v82 offset:12288
    s_waitcnt lgkmcnt(4)
    v_mfma_f32_32x32x16_bf16 v[12:27], v[112:115], v[44:47], v[12:27]
    ds_read_b128 v[68:71], v83 offset:8192
    v_mfma_f32_32x32x16_bf16 v[28:43], v[112:115], v[48:51], v[28:43]
    ds_read_b128 v[72:75], v83 offset:12288
    s_waitcnt lgkmcnt(4)
    v_mfma_f32_32x32x16_bf16 v[12:27], v[116:119], v[52:55], v[12:27]
    ds_read_b128 v[44:47], v80 offset:16384
    v_mfma_f32_32x32x16_bf16 v[28:43], v[116:119], v[56:59], v[28:43]
    ds_read_b128 v[48:51], v80 offset:20480
    s_waitcnt lgkmcnt(4)
    v_mfma_f32_32x32x16_bf16 v[12:27], v[120:123], v[60:63], v[12:27]
    ds_read_b128 v[52:55], v81 offset:16384
    v_mfma_f32_32x32x16_bf16 v[28:43], v[120:123], v[64:67], v[28:43]
    ds_read_b128 v[56:59], v81 offset:20480
    s_waitcnt lgkmcnt(4)
    v_mfma_f32_32x32x16_bf16 v[12:27], v[124:127], v[68:71], v[12:27]
    ds_read_b128 v[60:63], v82 offset:16384
    v_mfma_f32_32x32x16_bf16 v[28:43], v[124:127], v[72:75], v[28:43]
    ds_read_b128 v[64:67], v82 offset:20480
    s_waitcnt lgkmcnt(4)
    v_mfma_f32_32x32x16_bf16 v[12:27], v[128:131], v[44:47], v[12:27]
    ds_read_b128 v[68:71], v83 offset:16384
    v_mfma_f32_32x32x16_bf16 v[28:43], v[128:131], v[48:51], v[28:43]
    ds_read_b128 v[72:75], v83 offset:20480
    s_waitcnt vmcnt(0)
    s_mov_b64 exec, 1
    buffer_store_dword v94, v5, s[20:23], s51 offen sc1
    s_mov_b64 exec, -1
    s_waitcnt lgkmcnt(4)
    v_mfma_f32_32x32x16_bf16 v[12:27], v[132:135], v[52:55], v[12:27]
    ds_read_b128 v[44:47], v80 offset:24576
    v_mfma_f32_32x32x16_bf16 v[28:43], v[132:135], v[56:59], v[28:43]
    ds_read_b128 v[48:51], v80 offset:28672
    s_waitcnt lgkmcnt(4)
    v_mfma_f32_32x32x16_bf16 v[12:27], v[136:139], v[60:63], v[12:27]
    ds_read_b128 v[52:55], v81 offset:24576
    v_mfma_f32_32x32x16_bf16 v[28:43], v[136:139], v[64:67], v[28:43]
    ds_read_b128 v[56:59], v81 offset:28672
    s_waitcnt lgkmcnt(4)
    v_mfma_f32_32x32x16_bf16 v[12:27], v[140:143], v[68:71], v[12:27]
    ds_read_b128 v[60:63], v82 offset:24576
    v_mfma_f32_32x32x16_bf16 v[28:43], v[140:143], v[72:75], v[28:43]
    ds_read_b128 v[64:67], v82 offset:28672
    s_waitcnt lgkmcnt(4)
    v_mfma_f32_32x32x16_bf16 v[12:27], v[144:147], v[44:47], v[12:27]
    ds_read_b128 v[68:71], v83 offset:24576
    v_mfma_f32_32x32x16_bf16 v[28:43], v[144:147], v[48:51], v[28:43]
    ds_read_b128 v[72:75], v83 offset:28672
    s_waitcnt lgkmcnt(4)
    v_mfma_f32_32x32x16_bf16 v[12:27], v[148:151], v[52:55], v[12:27]
    s_barrier
    ds_read_b128 v[44:47], v80 offset:32768
    v_mfma_f32_32x32x16_bf16 v[28:43], v[148:151], v[56:59], v[28:43]
    ds_read_b128 v[48:51], v80 offset:36864
    s_waitcnt lgkmcnt(4)
    v_mfma_f32_32x32x16_bf16 v[12:27], v[152:155], v[60:63], v[12:27]
    ds_read_b128 v[52:55], v81 offset:32768
    v_mfma_f32_32x32x16_bf16 v[28:43], v[152:155], v[64:67], v[28:43]
    ds_read_b128 v[56:59], v81 offset:36864
    s_waitcnt lgkmcnt(4)
    v_mfma_f32_32x32x16_bf16 v[12:27], v[156:159], v[68:71], v[12:27]
    ds_read_b128 v[60:63], v82 offset:32768
    v_mfma_f32_32x32x16_bf16 v[28:43], v[156:159], v[72:75], v[28:43]
    ds_read_b128 v[64:67], v82 offset:36864
    s_waitcnt lgkmcnt(4)
    v_mfma_f32_32x32x16_bf16 v[12:27], v[160:163], v[44:47], v[12:27]
    ds_read_b128 v[68:71], v83 offset:32768
    v_mfma_f32_32x32x16_bf16 v[28:43], v[160:163], v[48:51], v[28:43]
    ds_read_b128 v[72:75], v83 offset:36864
    s_waitcnt lgkmcnt(4)
    v_mfma_f32_32x32x16_bf16 v[12:27], v[164:167], v[52:55], v[12:27]
    v_add_u32 v80, 40960, v80
    ds_read_b128 v[44:47], v80 offset:0
    v_mfma_f32_32x32x16_bf16 v[28:43], v[164:167], v[56:59], v[28:43]
    ds_read_b128 v[48:51], v80 offset:4096
    s_waitcnt lgkmcnt(4)
    v_mfma_f32_32x32x16_bf16 v[12:27], v[168:171], v[60:63], v[12:27]
    v_add_u32 v81, 40960, v81
    ds_read_b128 v[52:55], v81 offset:0
    v_mfma_f32_32x32x16_bf16 v[28:43], v[168:171], v[64:67], v[28:43]
    ds_read_b128 v[56:59], v81 offset:4096
    s_waitcnt lgkmcnt(4)
    v_mfma_f32_32x32x16_bf16 v[12:27], v[172:175], v[68:71], v[12:27]
    v_add_u32 v82, 40960, v82
    ds_read_b128 v[60:63], v82 offset:0
    v_mfma_f32_32x32x16_bf16 v[28:43], v[172:175], v[72:75], v[28:43]
    ds_read_b128 v[64:67], v82 offset:4096
    s_waitcnt lgkmcnt(4)
    v_mfma_f32_32x32x16_bf16 v[12:27], v[176:179], v[44:47], v[12:27]
    v_add_u32 v83, 40960, v83
    ds_read_b128 v[68:71], v83 offset:0
    v_mfma_f32_32x32x16_bf16 v[28:43], v[176:179], v[48:51], v[28:43]
    ds_read_b128 v[72:75], v83 offset:4096
    s_waitcnt lgkmcnt(4)
    v_mfma_f32_32x32x16_bf16 v[12:27], v[180:183], v[52:55], v[12:27]
    ds_read_b128 v[44:47], v80 offset:8192
    v_mfma_f32_32x32x16_bf16 v[28:43], v[180:183], v[56:59], v[28:43]
    ds_read_b128 v[48:51], v80 offset:12288
    s_waitcnt lgkmcnt(4)
    v_mfma_f32_32x32x16_bf16 v[12:27], v[184:187], v[60:63], v[12:27]
    ds_read_b128 v[52:55], v81 offset:8192
    v_mfma_f32_32x32x16_bf16 v[28:43], v[184:187], v[64:67], v[28:43]
    ds_read_b128 v[56:59], v81 offset:12288
    s_waitcnt lgkmcnt(4)
    v_mfma_f32_32x32x16_bf16 v[12:27], v[188:191], v[68:71], v[12:27]
    ds_read_b128 v[60:63], v82 offset:8192
    v_mfma_f32_32x32x16_bf16 v[28:43], v[188:191], v[72:75], v[28:43]
    ds_read_b128 v[64:67], v82 offset:12288
    s_waitcnt lgkmcnt(4)
    v_mfma_f32_32x32x16_bf16 v[12:27], v[192:195], v[44:47], v[12:27]
    ds_read_b128 v[68:71], v83 offset:8192
    v_mfma_f32_32x32x16_bf16 v[28:43], v[192:195], v[48:51], v[28:43]
    ds_read_b128 v[72:75], v83 offset:12288
    s_waitcnt lgkmcnt(4)
    v_mfma_f32_32x32x16_bf16 v[12:27], v[196:199], v[52:55], v[12:27]
    ds_read_b128 v[44:47], v80 offset:16384
    v_mfma_f32_32x32x16_bf16 v[28:43], v[196:199], v[56:59], v[28:43]
    ds_read_b128 v[48:51], v80 offset:20480
    s_waitcnt lgkmcnt(4)
    v_mfma_f32_32x32x16_bf16 v[12:27], v[200:203], v[60:63], v[12:27]
    ds_read_b128 v[52:55], v81 offset:16384
    v_and_b32 v2, 31, v1
    v_cmp_eq_u32 vcc, 20, v2
    v_mov_b32 v3, 0x3f803f80
    v_mfma_f32_32x32x16_bf16 v[28:43], v[200:203], v[64:67], v[28:43]
    ds_read_b128 v[56:59], v81 offset:20480
    s_waitcnt lgkmcnt(4)
    v_mfma_f32_32x32x16_bf16 v[12:27], v[204:207], v[68:71], v[12:27]
    ds_read_b128 v[60:63], v82 offset:16384
    v_cndmask_b32 v2, 0, v3, vcc
    v_mfma_f32_32x32x16_bf16 v[28:43], v[204:207], v[72:75], v[28:43]
    ds_read_b128 v[64:67], v82 offset:20480
    s_waitcnt lgkmcnt(4)
    v_mfma_f32_32x32x16_bf16 v[12:27], v[208:211], v[44:47], v[12:27]
    ds_read_b128 v[68:71], v83 offset:16384
    v_mov_b32 v176, v2
    v_mov_b32 v177, v2
    v_mov_b32 v178, v2
    v_mov_b32 v179, v2
    v_mfma_f32_32x32x16_bf16 v[28:43], v[208:211], v[48:51], v[28:43]
    ds_read_b128 v[72:75], v83 offset:20480
    s_waitcnt lgkmcnt(4)
    v_mfma_f32_32x32x16_bf16 v[12:27], v[212:215], v[52:55], v[12:27]
    ds_read_b128 v[44:47], v80 offset:24576
    v_mov_b32 v180, v2
    v_mov_b32 v181, v2
    v_mov_b32 v182, v2
    v_mov_b32 v183, v2
    v_mfma_f32_32x32x16_bf16 v[28:43], v[212:215], v[56:59], v[28:43]
    ds_read_b128 v[48:51], v80 offset:28672
    s_waitcnt lgkmcnt(4)
    v_mfma_f32_32x32x16_bf16 v[12:27], v[216:219], v[60:63], v[12:27]
    ds_read_b128 v[52:55], v81 offset:24576
    v_mov_b32 v184, v2
    v_mov_b32 v185, v2
    v_mov_b32 v186, v2
    v_mov_b32 v187, v2
    v_mfma_f32_32x32x16_bf16 v[28:43], v[216:219], v[64:67], v[28:43]
    ds_read_b128 v[56:59], v81 offset:28672
    s_waitcnt lgkmcnt(4)
    v_mfma_f32_32x32x16_bf16 v[12:27], v[220:223], v[68:71], v[12:27]
    ds_read_b128 v[60:63], v82 offset:24576
    v_mov_b32 v188, v2
    v_mov_b32 v189, v2
    v_mov_b32 v190, v2
    v_mov_b32 v191, v2
    v_mfma_f32_32x32x16_bf16 v[28:43], v[220:223], v[72:75], v[28:43]
    ds_read_b128 v[64:67], v82 offset:28672
    s_waitcnt lgkmcnt(4)
    v_mfma_f32_32x32x16_bf16 v[12:27], v[224:227], v[44:47], v[12:27]
    ds_read_b128 v[68:71], v83 offset:24576
    v_mov_b32 v96, 0
    v_mov_b32 v97, 0
    v_mov_b32 v98, 0
    v_mov_b32 v99, 0
    v_mfma_f32_32x32x16_bf16 v[28:43], v[224:227], v[48:51], v[28:43]
    ds_read_b128 v[72:75], v83 offset:28672
    s_waitcnt lgkmcnt(4)
    v_mfma_f32_32x32x16_bf16 v[12:27], v[228:231], v[52:55], v[12:27]
    ds_read_b128 v[44:47], v80 offset:32768
    v_mov_b32 v100, 0
    v_mov_b32 v101, 0
    v_mov_b32 v102, 0
    v_mov_b32 v103, 0
    v_mfma_f32_32x32x16_bf16 v[28:43], v[228:231], v[56:59], v[28:43]
    ds_read_b128 v[48:51], v80 offset:36864
    s_waitcnt lgkmcnt(4)
    v_mfma_f32_32x32x16_bf16 v[12:27], v[232:235], v[60:63], v[12:27]
    ds_read_b128 v[52:55], v81 offset:32768
    v_mov_b32 v104, 0
    v_mov_b32 v105, 0
    v_mov_b32 v106, 0
    v_mov_b32 v107, 0
    v_mfma_f32_32x32x16_bf16 v[28:43], v[232:235], v[64:67], v[28:43]
    ds_read_b128 v[56:59], v81 offset:36864
    s_waitcnt lgkmcnt(4)
    v_mfma_f32_32x32x16_bf16 v[12:27], v[236:239], v[68:71], v[12:27]
    ds_read_b128 v[60:63], v82 offset:32768
    v_mov_b32 v152, 0
    v_mov_b32 v153, 0
    v_mov_b32 v154, 0
    v_mov_b32 v155, 0
    v_mfma_f32_32x32x16_bf16 v[28:43], v[236:239], v[72:75], v[28:43]
    ds_read_b128 v[64:67], v82 offset:36864
    s_waitcnt lgkmcnt(4)
    v_mfma_f32_32x32x16_bf16 v[12:27], v[240:243], v[44:47], v[12:27]
    ds_read_b128 v[68:71], v83 offset:32768
    v_mfma_f32_32x32x16_bf16 v[28:43], v[240:243], v[48:51], v[28:43]
    ds_read_b128 v[72:75], v83 offset:36864
    s_waitcnt lgkmcnt(4)
    v_mfma_f32_32x32x16_bf16 v[12:27], v[244:247], v[52:55], v[12:27]
    v_mfma_f32_32x32x16_bf16 v[28:43], v[244:247], v[56:59], v[28:43]
    s_waitcnt lgkmcnt(2)
    v_mfma_f32_32x32x16_bf16 v[12:27], v[248:251], v[60:63], v[12:27]
    v_mfma_f32_32x32x16_bf16 v[28:43], v[248:251], v[64:67], v[28:43]
    s_waitcnt lgkmcnt(0)
    v_mfma_f32_32x32x16_bf16 v[12:27], v[252:255], v[68:71], v[12:27]
    v_mfma_f32_32x32x16_bf16 v[28:43], v[252:255], v[72:75], v[28:43]
    v_add_u32 v86, 512, v86
    s_add_u32 s51, s51, 262144
    s_add_u32 s64, s64, 1310720
    s_add_u32 s65, s65, 1310720
    s_add_u32 s66, s66, 1310720
    s_add_u32 s67, s67, 1310720
    s_call_b64 s[52:53], L_epQ
    s_branch L_ae
L_epQ:
    ds_read_b64 v[90:91], v86
    ds_read_b64 v[92:93], v86 offset:256
    ds_read_b128 v[44:47], v87 offset:0
    ds_read_b128 v[48:51], v87 offset:32
    ds_read_b128 v[52:55], v87 offset:64
    ds_read_b128 v[56:59], v87 offset:96
    s_waitcnt lgkmcnt(4)
    v_mul_f32 v92, s61, v92
    v_mul_f32 v93, s61, v93
    s_waitcnt lgkmcnt(0)
    s_nop 1
    v_pk_fma_f32 v[12:13], v[44:45], v[90:91], v[12:13] op_sel:[0,0,0] op_sel_hi:[1,0,1]
    v_pk_fma_f32 v[14:15], v[46:47], v[90:91], v[14:15] op_sel:[0,0,0] op_sel_hi:[1,0,1]
    v_pk_fma_f32 v[16:17], v[48:49], v[90:91], v[16:17] op_sel:[0,0,0] op_sel_hi:[1,0,1]
    v_pk_fma_f32 v[18:19], v[50:51], v[90:91], v[18:19] op_sel:[0,0,0] op_sel_hi:[1,0,1]
    v_pk_fma_f32 v[20:21], v[52:53], v[90:91], v[20:21] op_sel:[0,0,0] op_sel_hi:[1,0,1]
    v_pk_fma_f32 v[22:23], v[54:55], v[90:91], v[22:23] op_sel:[0,0,0] op_sel_hi:[1,0,1]
    v_pk_fma_f32 v[24:25], v[56:57], v[90:91], v[24:25] op_sel:[0,0,0] op_sel_hi:[1,0,1]
    v_pk_fma_f32 v[26:27], v[58:59], v[90:91], v[26:27] op_sel:[0,0,0] op_sel_hi:[1,0,1]
    v_pk_mul_f32 v[12:13], v[12:13], v[92:93] op_sel:[0,0] op_sel_hi:[1,0]
    v_pk_mul_f32 v[14:15], v[14:15], v[92:93] op_sel:[0,0] op_sel_hi:[1,0]
    v_pk_mul_f32 v[16:17], v[16:17], v[92:93] op_sel:[0,0] op_sel_hi:[1,0]
    v_pk_mul_f32 v[18:19], v[18:19], v[92:93] op_sel:[0,0] op_sel_hi:[1,0]
    v_pk_mul_f32 v[20:21], v[20:21], v[92:93] op_sel:[0,0] op_sel_hi:[1,0]
    v_pk_mul_f32 v[22:23], v[22:23], v[92:93] op_sel:[0,0] op_sel_hi:[1,0]
    v_pk_mul_f32 v[24:25], v[24:25], v[92:93] op_sel:[0,0] op_sel_hi:[1,0]
    v_pk_mul_f32 v[26:27], v[26:27], v[92:93] op_sel:[0,0] op_sel_hi:[1,0]
    v_cvt_pk_bf16_f32 v60, v12, v13
    v_cvt_pk_bf16_f32 v61, v14, v15
    v_cvt_pk_bf16_f32 v64, v16, v17
    v_cvt_pk_bf16_f32 v65, v18, v19
    v_cvt_pk_bf16_f32 v68, v20, v21
    v_cvt_pk_bf16_f32 v69, v22, v23
    v_cvt_pk_bf16_f32 v72, v24, v25
    v_cvt_pk_bf16_f32 v73, v26, v27
    v_pk_fma_f32 v[28:29], v[44:45], v[90:91], v[28:29] op_sel:[0,1,0] op_sel_hi:[1,1,1]
    v_pk_fma_f32 v[30:31], v[46:47], v[90:91], v[30:31] op_sel:[0,1,0] op_sel_hi:[1,1,1]
    v_pk_fma_f32 v[32:33], v[48:49], v[90:91], v[32:33] op_sel:[0,1,0] op_sel_hi:[1,1,1]
    v_pk_fma_f32 v[34:35], v[50:51], v[90:91], v[34:35] op_sel:[0,1,0] op_sel_hi:[1,1,1]
    v_pk_fma_f32 v[36:37], v[52:53], v[90:91], v[36:37] op_sel:[0,1,0] op_sel_hi:[1,1,1]
    v_pk_fma_f32 v[38:39], v[54:55], v[90:91], v[38:39] op_sel:[0,1,0] op_sel_hi:[1,1,1]
    v_pk_fma_f32 v[40:41], v[56:57], v[90:91], v[40:41] op_sel:[0,1,0] op_sel_hi:[1,1,1]
    v_pk_fma_f32 v[42:43], v[58:59], v[90:91], v[42:43] op_sel:[0,1,0] op_sel_hi:[1,1,1]
    v_pk_mul_f32 v[28:29], v[28:29], v[92:93] op_sel:[0,1] op_sel_hi:[1,1]
    v_pk_mul_f32 v[30:31], v[30:31], v[92:93] op_sel:[0,1] op_sel_hi:[1,1]
    v_pk_mul_f32 v[32:33], v[32:33], v[92:93] op_sel:[0,1] op_sel_hi:[1,1]
    v_pk_mul_f32 v[34:35], v[34:35], v[92:93] op_sel:[0,1] op_sel_hi:[1,1]
    v_pk_mul_f32 v[36:37], v[36:37], v[92:93] op_sel:[0,1] op_sel_hi:[1,1]
    v_pk_mul_f32 v[38:39], v[38:39], v[92:93] op_sel:[0,1] op_sel_hi:[1,1]
    v_pk_mul_f32 v[40:41], v[40:41], v[92:93] op_sel:[0,1] op_sel_hi:[1,1]
    v_pk_mul_f32 v[42:43], v[42:43], v[92:93] op_sel:[0,1] op_sel_hi:[1,1]
    v_cvt_pk_bf16_f32 v62, v28, v29
    v_cvt_pk_bf16_f32 v63, v30, v31
    v_cvt_pk_bf16_f32 v66, v32, v33
    v_cvt_pk_bf16_f32 v67, v34, v35
    v_cvt_pk_bf16_f32 v70, v36, v37
    v_cvt_pk_bf16_f32 v71, v38, v39
    v_cvt_pk_bf16_f32 v74, v40, v41
    v_cvt_pk_bf16_f32 v75, v42, v43
    buffer_store_dwordx4 v[60:63], v95, s[20:23], s64 offen sc1
    buffer_store_dwordx4 v[64:67], v95, s[20:23], s65 offen sc1
    buffer_store_dwordx4 v[68:71], v95, s[20:23], s66 offen sc1
    buffer_store_dwordx4 v[72:75], v95, s[20:23], s67 offen sc1
    s_nop 1
    s_setpc_b64 s[52:53]
L_aV:
    s_waitcnt lgkmcnt(4)
    v_mfma_f32_32x32x16_bf16 v[12:27], v[44:47], v[96:99], 0
    ds_read_b128 v[60:63], v82 offset:49152
    ds_read_b128 v[64:67], v82 offset:53248
    v_mfma_f32_32x32x16_bf16 v[28:43], v[48:51], v[96:99], 0
    ds_read_b64_tr_b16 v[104:105], v84 offset:57344
    ds_read_b64_tr_b16 v[106:107], v84 offset:58368
    s_waitcnt lgkmcnt(4)
    v_mfma_f32_32x32x16_bf16 v[12:27], v[52:55], v[100:103], v[12:27]
    ds_read_b128 v[68:71], v83 offset:49152
    ds_read_b128 v[72:75], v83 offset:53248
    v_mfma_f32_32x32x16_bf16 v[28:43], v[56:59], v[100:103], v[28:43]
    ds_read_b64_tr_b16 v[108:109], v84 offset:61440
    ds_read_b64_tr_b16 v[110:111], v84 offset:62464
    s_call_b64 s[52:53], L_sx
    v_mfma_f32_4x4x4_16b_bf16 v[76:79], v[88:89], v[96:97], 0
    v_mfma_f32_4x4x4_16b_bf16 v[90:93], v[88:89], v[98:99], 0
    s_nop 0
    v_mfma_f32_4x4x4_16b_bf16 v[76:79], v[88:89], v[100:101], v[76:79]
    v_mfma_f32_4x4x4_16b_bf16 v[90:93], v[88:89], v[102:103], v[90:93]
    s_nop 0
    s_waitcnt lgkmcnt(4)
    v_mfma_f32_32x32x16_bf16 v[12:27], v[60:63], v[104:107], v[12:27]
    s_barrier
    v_subrev_u32 v80, 81920, v80
    v_subrev_u32 v84, 81920, v84
    ds_read_b128 v[44:47], v80 offset:0
    ds_read_b128 v[48:51], v80 offset:4096
    v_mfma_f32_32x32x16_bf16 v[28:43], v[64:67], v[104:107], v[28:43]
    ds_read_b64_tr_b16 v[112:113], v84 offset:0
    ds_read_b64_tr_b16 v[114:115], v84 offset:1024
    s_waitcnt lgkmcnt(4)
    v_mfma_f32_32x32x16_bf16 v[12:27], v[68:71], v[108:111], v[12:27]
    v_subrev_u32 v81, 81920, v81
    ds_read_b128 v[52:55], v81 offset:0
    ds_read_b128 v[56:59], v81 offset:4096
    v_mfma_f32_32x32x16_bf16 v[28:43], v[72:75], v[108:111], v[28:43]
    ds_read_b64_tr_b16 v[116:117], v84 offset:4096
    ds_read_b64_tr_b16 v[118:119], v84 offset:5120
    s_waitcnt lgkmcnt(4)
    v_mfma_f32_32x32x16_bf16 v[12:27], v[44:47], v[112:115], v[12:27]
    v_subrev_u32 v82, 81920, v82
    ds_read_b128 v[60:63], v82 offset:0
    ds_read_b128 v[64:67], v82 offset:4096
    v_mfma_f32_32x32x16_bf16 v[28:43], v[48:51], v[112:115], v[28:43]
    ds_read_b64_tr_b16 v[120:121], v84 offset:8192
    ds_read_b64_tr_b16 v[122:123], v84 offset:9216
    s_waitcnt lgkmcnt(4)
    v_mfma_f32_32x32x16_bf16 v[12:27], v[52:55], v[116:119], v[12:27]
    v_subrev_u32 v83, 81920, v83
    ds_read_b128 v[68:71], v83 offset:0
    ds_read_b128 v[72:75], v83 offset:4096
    v_mfma_f32_32x32x16_bf16 v[28:43], v[56:59], v[116:119], v[28:43]
    ds_read_b64_tr_b16 v[124:125], v84 offset:12288
    ds_read_b64_tr_b16 v[126:127], v84 offset:13312
    v_mfma_f32_4x4x4_16b_bf16 v[76:79], v[88:89], v[104:105], v[76:79]
    v_mfma_f32_4x4x4_16b_bf16 v[90:93], v[88:89], v[106:107], v[90:93]
    s_nop 0
    v_mfma_f32_4x4x4_16b_bf16 v[76:79], v[88:89], v[108:109], v[76:79]
    v_mfma_f32_4x4x4_16b_bf16 v[90:93], v[88:89], v[110:111], v[90:93]
    s_nop 0
    v_mfma_f32_4x4x4_16b_bf16 v[76:79], v[88:89], v[112:113], v[76:79]
    v_mfma_f32_4x4x4_16b_bf16 v[90:93], v[88:89], v[114:115], v[90:93]
    s_nop 0
    v_mfma_f32_4x4x4_16b_bf16 v[76:79], v[88:89], v[116:117], v[76:79]
    v_mfma_f32_4x4x4_16b_bf16 v[90:93], v[88:89], v[118:119], v[90:93]
    s_nop 0
    s_waitcnt lgkmcnt(4)
    v_mfma_f32_32x32x16_bf16 v[12:27], v[60:63], v[120:123], v[12:27]
    s_barrier
    ds_read_b128 v[44:47], v80 offset:24576
    ds_read_b128 v[48:51], v80 offset:28672
    v_mfma_f32_32x32x16_bf16 v[28:43], v[64:67], v[120:123], v[28:43]
    ds_read_b64_tr_b16 v[128:129], v84 offset:24576
    ds_read_b64_tr_b16 v[130:131], v84 offset:25600
    s_waitcnt lgkmcnt(4)
    v_mfma_f32_32x32x16_bf16 v[12:27], v[68:71], v[124:127], v[12:27]
    ds_read_b128 v[52:55], v81 offset:24576
    ds_read_b128 v[56:59], v81 offset:28672
    v_mfma_f32_32x32x16_bf16 v[28:43], v[72:75], v[124:127], v[28:43]
    ds_read_b64_tr_b16 v[132:133], v84 offset:28672
    ds_read_b64_tr_b16 v[134:135], v84 offset:29696
    s_waitcnt lgkmcnt(4)
    v_mfma_f32_32x32x16_bf16 v[12:27], v[44:47], v[128:131], v[12:27]
    ds_read_b128 v[60:63], v82 offset:24576
    ds_read_b128 v[64:67], v82 offset:28672
    v_mfma_f32_32x32x16_bf16 v[28:43], v[48:51], v[128:131], v[28:43]
    ds_read_b64_tr_b16 v[136:137], v84 offset:32768
    ds_read_b64_tr_b16 v[138:139], v84 offset:33792
    s_waitcnt lgkmcnt(4)
    v_mfma_f32_32x32x16_bf16 v[12:27], v[52:55], v[132:135], v[12:27]
    ds_read_b128 v[68:71], v83 offset:24576
    ds_read_b128 v[72:75], v83 offset:28672
    v_mfma_f32_32x32x16_bf16 v[28:43], v[56:59], v[132:135], v[28:43]
    ds_read_b64_tr_b16 v[140:141], v84 offset:36864
    ds_read_b64_tr_b16 v[142:143], v84 offset:37888
    v_mfma_f32_4x4x4_16b_bf16 v[76:79], v[88:89], v[120:121], v[76:79]
    v_mfma_f32_4x4x4_16b_bf16 v[90:93], v[88:89], v[122:123], v[90:93]
    s_nop 0
    v_mfma_f32_4x4x4_16b_bf16 v[76:79], v[88:89], v[124:125], v[76:79]
    v_mfma_f32_4x4x4_16b_bf16 v[90:93], v[88:89], v[126:127], v[90:93]
    s_nop 0
    v_mfma_f32_4x4x4_16b_bf16 v[76:79], v[88:89], v[128:129], v[76:79]
    v_mfma_f32_4x4x4_16b_bf16 v[90:93], v[88:89], v[130:131], v[90:93]
    s_nop 0
    v_mfma_f32_4x4x4_16b_bf16 v[76:79], v[88:89], v[132:133], v[76:79]
    v_mfma_f32_4x4x4_16b_bf16 v[90:93], v[88:89], v[134:135], v[90:93]
    s_nop 0
    s_waitcnt lgkmcnt(4)
    v_mfma_f32_32x32x16_bf16 v[12:27], v[60:63], v[136:139], v[12:27]
    s_barrier
    ds_read_b128 v[44:47], v80 offset:49152
    ds_read_b128 v[48:51], v80 offset:53248
    v_mfma_f32_32x32x16_bf16 v[28:43], v[64:67], v[136:139], v[28:43]
    ds_read_b64_tr_b16 v[144:145], v84 offset:49152
    ds_read_b64_tr_b16 v[146:147], v84 offset:50176
    s_waitcnt lgkmcnt(4)
    v_mfma_f32_32x32x16_bf16 v[12:27], v[68:71], v[140:143], v[12:27]
    ds_read_b128 v[52:55], v81 offset:49152
    ds_read_b128 v[56:59], v81 offset:53248
    v_mfma_f32_32x32x16_bf16 v[28:43], v[72:75], v[140:143], v[28:43]
    ds_read_b64_tr_b16 v[148:149], v84 offset:53248
    ds_read_b64_tr_b16 v[150:151], v84 offset:54272
    s_waitcnt lgkmcnt(4)
    v_mfma_f32_32x32x16_bf16 v[12:27], v[44:47], v[144:147], v[12:27]
    ds_read_b128 v[60:63], v82 offset:49152
    ds_read_b128 v[64:67], v82 offset:53248
    v_mfma_f32_32x32x16_bf16 v[28:43], v[48:51], v[144:147], v[28:43]
    ds_read_b64_tr_b16 v[152:153], v84 offset:57344
    ds_read_b64_tr_b16 v[154:155], v84 offset:58368
    s_waitcnt lgkmcnt(4)
    v_mfma_f32_32x32x16_bf16 v[12:27], v[52:55], v[148:151], v[12:27]
    ds_read_b128 v[68:71], v83 offset:49152
    ds_read_b128 v[72:75], v83 offset:53248
    v_mfma_f32_32x32x16_bf16 v[28:43], v[56:59], v[148:151], v[28:43]
    ds_read_b64_tr_b16 v[156:157], v84 offset:61440
    ds_read_b64_tr_b16 v[158:159], v84 offset:62464
    v_mfma_f32_4x4x4_16b_bf16 v[76:79], v[88:89], v[136:137], v[76:79]
    v_mfma_f32_4x4x4_16b_bf16 v[90:93], v[88:89], v[138:139], v[90:93]
    s_nop 0
    v_mfma_f32_4x4x4_16b_bf16 v[76:79], v[88:89], v[140:141], v[76:79]
    v_mfma_f32_4x4x4_16b_bf16 v[90:93], v[88:89], v[142:143], v[90:93]
    s_nop 0
    v_mfma_f32_4x4x4_16b_bf16 v[76:79], v[88:89], v[144:145], v[76:79]
    v_mfma_f32_4x4x4_16b_bf16 v[90:93], v[88:89], v[146:147], v[90:93]
    s_nop 0
    v_mfma_f32_4x4x4_16b_bf16 v[76:79], v[88:89], v[148:149], v[76:79]
    v_mfma_f32_4x4x4_16b_bf16 v[90:93], v[88:89], v[150:151], v[90:93]
    s_nop 0
    s_waitcnt lgkmcnt(4)
    v_mfma_f32_32x32x16_bf16 v[12:27], v[60:63], v[152:155], v[12:27]
    s_barrier
    v_add_u32 v80, 81920, v80
    v_add_u32 v84, 81920, v84
    ds_read_b128 v[44:47], v80 offset:0
    ds_read_b128 v[48:51], v80 offset:4096
    v_mfma_f32_32x32x16_bf16 v[28:43], v[64:67], v[152:155], v[28:43]
    ds_read_b64_tr_b16 v[160:161], v84 offset:0
    ds_read_b64_tr_b16 v[162:163], v84 offset:1024
    s_waitcnt lgkmcnt(4)
    v_mfma_f32_32x32x16_bf16 v[12:27], v[68:71], v[156:159], v[12:27]
    v_add_u32 v81, 81920, v81
    ds_read_b128 v[52:55], v81 offset:0
    ds_read_b128 v[56:59], v81 offset:4096
    v_mfma_f32_32x32x16_bf16 v[28:43], v[72:75], v[156:159], v[28:43]
    ds_read_b64_tr_b16 v[164:165], v84 offset:4096
    ds_read_b64_tr_b16 v[166:167], v84 offset:5120
    s_waitcnt lgkmcnt(4)
    v_mfma_f32_32x32x16_bf16 v[12:27], v[44:47], v[160:163], v[12:27]
    v_add_u32 v82, 81920, v82
    ds_read_b128 v[60:63], v82 offset:0
    ds_read_b128 v[64:67], v82 offset:4096
    v_mfma_f32_32x32x16_bf16 v[28:43], v[48:51], v[160:163], v[28:43]
    ds_read_b64_tr_b16 v[168:169], v84 offset:8192
    ds_read_b64_tr_b16 v[170:171], v84 offset:9216
    s_waitcnt lgkmcnt(4)
    v_mfma_f32_32x32x16_bf16 v[12:27], v[52:55], v[164:167], v[12:27]
    v_add_u32 v83, 81920, v83
    ds_read_b128 v[68:71], v83 offset:0
    ds_read_b128 v[72:75], v83 offset:4096
    v_mfma_f32_32x32x16_bf16 v[28:43], v[56:59], v[164:167], v[28:43]
    ds_read_b64_tr_b16 v[172:173], v84 offset:12288
    ds_read_b64_tr_b16 v[174:175], v84 offset:13312
    v_mfma_f32_4x4x4_16b_bf16 v[76:79], v[88:89], v[152:153], v[76:79]
    v_mfma_f32_4x4x4_16b_bf16 v[90:93], v[88:89], v[154:155], v[90:93]
    s_nop 0
    v_mfma_f32_4x4x4_16b_bf16 v[76:79], v[88:89], v[156:157], v[76:79]
    v_mfma_f32_4x4x4_16b_bf16 v[90:93], v[88:89], v[158:159], v[90:93]
    s_nop 0
    v_mfma_f32_4x4x4_16b_bf16 v[76:79], v[88:89], v[160:161], v[76:79]
    v_mfma_f32_4x4x4_16b_bf16 v[90:93], v[88:89], v[162:163], v[90:93]
    s_nop 0
    v_mfma_f32_4x4x4_16b_bf16 v[76:79], v[88:89], v[164:165], v[76:79]
    v_mfma_f32_4x4x4_16b_bf16 v[90:93], v[88:89], v[166:167], v[90:93]
    s_nop 0
    s_waitcnt lgkmcnt(4)
    v_mfma_f32_32x32x16_bf16 v[12:27], v[60:63], v[168:171], v[12:27]
    s_barrier
    ds_read_b128 v[44:47], v80 offset:24576
    ds_read_b128 v[48:51], v80 offset:28672
    v_mfma_f32_32x32x16_bf16 v[28:43], v[64:67], v[168:171], v[28:43]
    ds_read_b64_tr_b16 v[176:177], v84 offset:24576
    ds_read_b64_tr_b16 v[178:179], v84 offset:25600
    s_waitcnt lgkmcnt(4)
    v_mfma_f32_32x32x16_bf16 v[12:27], v[68:71], v[172:175], v[12:27]
    ds_read_b128 v[52:55], v81 offset:24576
    ds_read_b128 v[56:59], v81 offset:28672
    v_mfma_f32_32x32x16_bf16 v[28:43], v[72:75], v[172:175], v[28:43]
    ds_read_b64_tr_b16 v[180:181], v84 offset:28672
    ds_read_b64_tr_b16 v[182:183], v84 offset:29696
    s_waitcnt lgkmcnt(4)
    v_mfma_f32_32x32x16_bf16 v[12:27], v[44:47], v[176:179], v[12:27]
    ds_read_b128 v[60:63], v82 offset:24576
    ds_read_b128 v[64:67], v82 offset:28672
    v_mfma_f32_32x32x16_bf16 v[28:43], v[48:51], v[176:179], v[28:43]
    ds_read_b64_tr_b16 v[184:185], v84 offset:32768
    ds_read_b64_tr_b16 v[186:187], v84 offset:33792
    s_waitcnt lgkmcnt(4)
    v_mfma_f32_32x32x16_bf16 v[12:27], v[52:55], v[180:183], v[12:27]
    ds_read_b128 v[68:71], v83 offset:24576
    ds_read_b128 v[72:75], v83 offset:28672
    v_mfma_f32_32x32x16_bf16 v[28:43], v[56:59], v[180:183], v[28:43]
    ds_read_b64_tr_b16 v[188:189], v84 offset:36864
    ds_read_b64_tr_b16 v[190:191], v84 offset:37888
    v_mfma_f32_4x4x4_16b_bf16 v[76:79], v[88:89], v[168:169], v[76:79]
    v_mfma_f32_4x4x4_16b_bf16 v[90:93], v[88:89], v[170:171], v[90:93]
    s_nop 0
    v_mfma_f32_4x4x4_16b_bf16 v[76:79], v[88:89], v[172:173], v[76:79]
    v_mfma_f32_4x4x4_16b_bf16 v[90:93], v[88:89], v[174:175], v[90:93]
    s_nop 0
    v_mfma_f32_4x4x4_16b_bf16 v[76:79], v[88:89], v[176:177], v[76:79]
    v_mfma_f32_4x4x4_16b_bf16 v[90:93], v[88:89], v[178:179], v[90:93]
    s_nop 0
    v_mfma_f32_4x4x4_16b_bf16 v[76:79], v[88:89], v[180:181], v[76:79]
    v_mfma_f32_4x4x4_16b_bf16 v[90:93], v[88:89], v[182:183], v[90:93]
    s_nop 0
    s_waitcnt lgkmcnt(4)
    v_mfma_f32_32x32x16_bf16 v[12:27], v[60:63], v[184:187], v[12:27]
    s_barrier
    ds_read_b128 v[44:47], v80 offset:49152
    ds_read_b128 v[48:51], v80 offset:53248
    v_mfma_f32_32x32x16_bf16 v[28:43], v[64:67], v[184:187], v[28:43]
    ds_read_b64_tr_b16 v[192:193], v84 offset:49152
    ds_read_b64_tr_b16 v[194:195], v84 offset:50176
    s_waitcnt lgkmcnt(4)
    v_mfma_f32_32x32x16_bf16 v[12:27], v[68:71], v[188:191], v[12:27]
    ds_read_b128 v[52:55], v81 offset:49152
    ds_read_b128 v[56:59], v81 offset:53248
    v_mfma_f32_32x32x16_bf16 v[28:43], v[72:75], v[188:191], v[28:43]
    ds_read_b64_tr_b16 v[196:197], v84 offset:53248
    ds_read_b64_tr_b16 v[198:199], v84 offset:54272
    s_waitcnt lgkmcnt(4)
    v_mfma_f32_32x32x16_bf16 v[12:27], v[44:47], v[192:195], v[12:27]
    ds_read_b128 v[60:63], v82 offset:49152
    ds_read_b128 v[64:67], v82 offset:53248
    v_mfma_f32_32x32x16_bf16 v[28:43], v[48:51], v[192:195], v[28:43]
    ds_read_b64_tr_b16 v[200:201], v84 offset:57344
    ds_read_b64_tr_b16 v[202:203], v84 offset:58368
    s_waitcnt lgkmcnt(4)
    v_mfma_f32_32x32x16_bf16 v[12:27], v[52:55], v[196:199], v[12:27]
    ds_read_b128 v[68:71], v83 offset:49152
    ds_read_b128 v[72:75], v83 offset:53248
    v_mfma_f32_32x32x16_bf16 v[28:43], v[56:59], v[196:199], v[28:43]
    ds_read_b64_tr_b16 v[204:205], v84 offset:61440
    ds_read_b64_tr_b16 v[206:207], v84 offset:62464
    v_mfma_f32_4x4x4_16b_bf16 v[76:79], v[88:89], v[184:185], v[76:79]
    v_mfma_f32_4x4x4_16b_bf16 v[90:93], v[88:89], v[186:187], v[90:93]
    s_nop 0
    v_mfma_f32_4x4x4_16b_bf16 v[76:79], v[88:89], v[188:189], v[76:79]
    v_mfma_f32_4x4x4_16b_bf16 v[90:93], v[88:89], v[190:191], v[90:93]
    s_nop 0
    v_mfma_f32_4x4x4_16b_bf16 v[76:79], v[88:89], v[192:193], v[76:79]
    v_mfma_f32_4x4x4_16b_bf16 v[90:93], v[88:89], v[194:195], v[90:93]
    s_nop 0
    v_mfma_f32_4x4x4_16b_bf16 v[76:79], v[88:89], v[196:197], v[76:79]
    v_mfma_f32_4x4x4_16b_bf16 v[90:93], v[88:89], v[198:199], v[90:93]
    s_nop 0
    s_waitcnt lgkmcnt(4)
    v_mfma_f32_32x32x16_bf16 v[12:27], v[60:63], v[200:203], v[12:27]
    s_barrier
    v_subrev_u32 v80, 81920, v80
    v_subrev_u32 v84, 81920, v84
    ds_read_b128 v[44:47], v80 offset:0
    ds_read_b128 v[48:51], v80 offset:4096
    v_mfma_f32_32x32x16_bf16 v[28:43], v[64:67], v[200:203], v[28:43]
    ds_read_b64_tr_b16 v[208:209], v84 offset:0
    ds_read_b64_tr_b16 v[210:211], v84 offset:1024
    s_waitcnt lgkmcnt(4)
    v_mfma_f32_32x32x16_bf16 v[12:27], v[68:71], v[204:207], v[12:27]
    v_subrev_u32 v81, 81920, v81
    ds_read_b128 v[52:55], v81 offset:0
    ds_read_b128 v[56:59], v81 offset:4096
    v_mfma_f32_32x32x16_bf16 v[28:43], v[72:75], v[204:207], v[28:43]
    ds_read_b64_tr_b16 v[212:213], v84 offset:4096
    ds_read_b64_tr_b16 v[214:215], v84 offset:5120
    s_waitcnt lgkmcnt(4)
    v_mfma_f32_32x32x16_bf16 v[12:27], v[44:47], v[208:211], v[12:27]
    v_subrev_u32 v82, 81920, v82
    ds_read_b128 v[60:63], v82 offset:0
    ds_read_b128 v[64:67], v82 offset:4096
    v_mfma_f32_32x32x16_bf16 v[28:43], v[48:51], v[208:211], v[28:43]
    ds_read_b64_tr_b16 v[216:217], v84 offset:8192
    ds_read_b64_tr_b16 v[218:219], v84 offset:9216
    s_waitcnt lgkmcnt(4)
    v_mfma_f32_32x32x16_bf16 v[12:27], v[52:55], v[212:215], v[12:27]
    v_subrev_u32 v83, 81920, v83
    ds_read_b128 v[68:71], v83 offset:0
    ds_read_b128 v[72:75], v83 offset:4096
    v_mfma_f32_32x32x16_bf16 v[28:43], v[56:59], v[212:215], v[28:43]
    ds_read_b64_tr_b16 v[220:221], v84 offset:12288
    ds_read_b64_tr_b16 v[222:223], v84 offset:13312
    v_mfma_f32_4x4x4_16b_bf16 v[76:79], v[88:89], v[200:201], v[76:79]
    v_mfma_f32_4x4x4_16b_bf16 v[90:93], v[88:89], v[202:203], v[90:93]
    s_nop 0
    v_mfma_f32_4x4x4_16b_bf16 v[76:79], v[88:89], v[204:205], v[76:79]
    v_mfma_f32_4x4x4_16b_bf16 v[90:93], v[88:89], v[206:207], v[90:93]
    s_nop 0
    v_mfma_f32_4x4x4_16b_bf16 v[76:79], v[88:89], v[208:209], v[76:79]
    v_mfma_f32_4x4x4_16b_bf16 v[90:93], v[88:89], v[210:211], v[90:93]
    s_nop 0
    v_mfma_f32_4x4x4_16b_bf16 v[76:79], v[88:89], v[212:213], v[76:79]
    v_mfma_f32_4x4x4_16b_bf16 v[90:93], v[88:89], v[214:215], v[90:93]
    s_nop 0
    s_waitcnt lgkmcnt(4)
    v_mfma_f32_32x32x16_bf16 v[12:27], v[60:63], v[216:219], v[12:27]
    s_barrier
    ds_read_b128 v[44:47], v80 offset:24576
    ds_read_b128 v[48:51], v80 offset:28672
    v_mfma_f32_32x32x16_bf16 v[28:43], v[64:67], v[216:219], v[28:43]
    ds_read_b64_tr_b16 v[224:225], v84 offset:24576
    ds_read_b64_tr_b16 v[226:227], v84 offset:25600
    s_waitcnt lgkmcnt(4)
    v_mfma_f32_32x32x16_bf16 v[12:27], v[68:71], v[220:223], v[12:27]
    ds_read_b128 v[52:55], v81 offset:24576
    ds_read_b128 v[56:59], v81 offset:28672
    v_mfma_f32_32x32x16_bf16 v[28:43], v[72:75], v[220:223], v[28:43]
    ds_read_b64_tr_b16 v[228:229], v84 offset:28672
    ds_read_b64_tr_b16 v[230:231], v84 offset:29696
    s_waitcnt lgkmcnt(4)
    v_mfma_f32_32x32x16_bf16 v[12:27], v[44:47], v[224:227], v[12:27]
    ds_read_b128 v[60:63], v82 offset:24576
    ds_read_b128 v[64:67], v82 offset:28672
    v_mfma_f32_32x32x16_bf16 v[28:43], v[48:51], v[224:227], v[28:43]
    ds_read_b64_tr_b16 v[232:233], v84 offset:32768
    ds_read_b64_tr_b16 v[234:235], v84 offset:33792
    s_waitcnt lgkmcnt(4)
    v_mfma_f32_32x32x16_bf16 v[12:27], v[52:55], v[228:231], v[12:27]
    ds_read_b128 v[68:71], v83 offset:24576
    ds_read_b128 v[72:75], v83 offset:28672
    v_mfma_f32_32x32x16_bf16 v[28:43], v[56:59], v[228:231], v[28:43]
    ds_read_b64_tr_b16 v[236:237], v84 offset:36864
    ds_read_b64_tr_b16 v[238:239], v84 offset:37888
    v_mfma_f32_4x4x4_16b_bf16 v[76:79], v[88:89], v[216:217], v[76:79]
    v_mfma_f32_4x4x4_16b_bf16 v[90:93], v[88:89], v[218:219], v[90:93]
    s_nop 0
    v_mfma_f32_4x4x4_16b_bf16 v[76:79], v[88:89], v[220:221], v[76:79]
    v_mfma_f32_4x4x4_16b_bf16 v[90:93], v[88:89], v[222:223], v[90:93]
    s_nop 0
    v_mfma_f32_4x4x4_16b_bf16 v[76:79], v[88:89], v[224:225], v[76:79]
    v_mfma_f32_4x4x4_16b_bf16 v[90:93], v[88:89], v[226:227], v[90:93]
    s_nop 0
    v_mfma_f32_4x4x4_16b_bf16 v[76:79], v[88:89], v[228:229], v[76:79]
    v_mfma_f32_4x4x4_16b_bf16 v[90:93], v[88:89], v[230:231], v[90:93]
    s_nop 0
    s_waitcnt lgkmcnt(4)
    v_mfma_f32_32x32x16_bf16 v[12:27], v[60:63], v[232:235], v[12:27]
    s_barrier
    ds_read_b128 v[44:47], v80 offset:49152
    ds_read_b128 v[48:51], v80 offset:53248
    v_mfma_f32_32x32x16_bf16 v[28:43], v[64:67], v[232:235], v[28:43]
    ds_read_b64_tr_b16 v[240:241], v84 offset:49152
    ds_read_b64_tr_b16 v[242:243], v84 offset:50176
    s_waitcnt lgkmcnt(4)
    v_mfma_f32_32x32x16_bf16 v[12:27], v[68:71], v[236:239], v[12:27]
    ds_read_b128 v[52:55], v81 offset:49152
    ds_read_b128 v[56:59], v81 offset:53248
    v_mfma_f32_32x32x16_bf16 v[28:43], v[72:75], v[236:239], v[28:43]
    ds_read_b64_tr_b16 v[244:245], v84 offset:53248
    ds_read_b64_tr_b16 v[246:247], v84 offset:54272
    s_waitcnt lgkmcnt(4)
    v_mfma_f32_32x32x16_bf16 v[12:27], v[44:47], v[240:243], v[12:27]
    ds_read_b128 v[60:63], v82 offset:49152
    ds_read_b128 v[64:67], v82 offset:53248
    v_mfma_f32_32x32x16_bf16 v[28:43], v[48:51], v[240:243], v[28:43]
    ds_read_b64_tr_b16 v[248:249], v84 offset:57344
    ds_read_b64_tr_b16 v[250:251], v84 offset:58368
    s_waitcnt lgkmcnt(4)
    v_mfma_f32_32x32x16_bf16 v[12:27], v[52:55], v[244:247], v[12:27]
    ds_read_b128 v[68:71], v83 offset:49152
    ds_read_b128 v[72:75], v83 offset:53248
    v_mfma_f32_32x32x16_bf16 v[28:43], v[56:59], v[244:247], v[28:43]
    ds_read_b64_tr_b16 v[252:253], v84 offset:61440
    ds_read_b64_tr_b16 v[254:255], v84 offset:62464
    v_mfma_f32_4x4x4_16b_bf16 v[76:79], v[88:89], v[232:233], v[76:79]
    v_mfma_f32_4x4x4_16b_bf16 v[90:93], v[88:89], v[234:235], v[90:93]
    s_nop 0
    v_mfma_f32_4x4x4_16b_bf16 v[76:79], v[88:89], v[236:237], v[76:79]
    v_mfma_f32_4x4x4_16b_bf16 v[90:93], v[88:89], v[238:239], v[90:93]
    s_nop 0
    v_mfma_f32_4x4x4_16b_bf16 v[76:79], v[88:89], v[240:241], v[76:79]
    v_mfma_f32_4x4x4_16b_bf16 v[90:93], v[88:89], v[242:243], v[90:93]
    s_nop 0
    v_mfma_f32_4x4x4_16b_bf16 v[76:79], v[88:89], v[244:245], v[76:79]
    v_mfma_f32_4x4x4_16b_bf16 v[90:93], v[88:89], v[246:247], v[90:93]
    s_nop 0
    s_waitcnt lgkmcnt(4)
    v_mfma_f32_32x32x16_bf16 v[12:27], v[60:63], v[248:251], v[12:27]
    v_mfma_f32_32x32x16_bf16 v[28:43], v[64:67], v[248:251], v[28:43]
    s_waitcnt lgkmcnt(0)
    v_mfma_f32_4x4x4_16b_bf16 v[76:79], v[88:89], v[248:249], v[76:79]
    v_mfma_f32_4x4x4_16b_bf16 v[90:93], v[88:89], v[250:251], v[90:93]
    s_nop 0
    v_mfma_f32_4x4x4_16b_bf16 v[76:79], v[88:89], v[252:253], v[76:79]
    v_mfma_f32_4x4x4_16b_bf16 v[90:93], v[88:89], v[254:255], v[90:93]
    s_nop 0
    s_waitcnt lgkmcnt(0)
    v_mfma_f32_32x32x16_bf16 v[12:27], v[68:71], v[252:255], v[12:27]
    v_mfma_f32_32x32x16_bf16 v[28:43], v[72:75], v[252:255], v[28:43]
    s_nop 0
    v_add_f32 v76, v76, v90
    v_add_f32 v77, v77, v90
    v_add_u32 v80, 81920, v80
    v_add_u32 v81, 81920, v81
    v_add_u32 v82, 81920, v82
    v_add_u32 v83, 81920, v83
    v_permlane32_swap_b32 v76, v77
    v_add_f32 v76, v76, v77
    s_call_b64 s[52:53], L_epV
    s_barrier
    ds_read_b128 v[44:47], v80 offset:0
    ds_read_b128 v[48:51], v80 offset:4096
    ds_read_b128 v[52:55], v81 offset:0
    ds_read_b128 v[56:59], v81 offset:4096
    ds_read_b128 v[60:63], v82 offset:0
    ds_read_b128 v[64:67], v82 offset:4096
    s_waitcnt lgkmcnt(4)
    v_mfma_f32_32x32x16_bf16 v[12:27], v[44:47], v[96:99], 0
    ds_read_b128 v[68:71], v83 offset:0
    v_mfma_f32_32x32x16_bf16 v[28:43], v[48:51], v[96:99], 0
    ds_read_b128 v[72:75], v83 offset:4096
    s_waitcnt lgkmcnt(4)
    v_mfma_f32_32x32x16_bf16 v[12:27], v[52:55], v[100:103], v[12:27]
    ds_read_b128 v[44:47], v80 offset:8192
    v_mfma_f32_32x32x16_bf16 v[28:43], v[56:59], v[100:103], v[28:43]
    ds_read_b128 v[48:51], v80 offset:12288
    s_waitcnt lgkmcnt(4)
    v_mfma_f32_32x32x16_bf16 v[12:27], v[60:63], v[104:107], v[12:27]
    ds_read_b128 v[52:55], v81 offset:8192
    v_mfma_f32_32x32x16_bf16 v[28:43], v[64:67], v[104:107], v[28:43]
    ds_read_b128 v[56:59], v81 offset:12288
    s_waitcnt lgkmcnt(4)
    v_mfma_f32_32x32x16_bf16 v[12:27], v[68:71], v[108:111], v[12:27]
    ds_read_b128 v[60:63], v82 offset:8192
    v_mfma_f32_32x32x16_bf16 v[28:43], v[72:75], v[108:111], v[28:43]
    ds_read_b128 v[64:67], v82 offset:12288
    s_waitcnt lgkmcnt(4)
    v_mfma_f32_32x32x16_bf16 v[12:27], v[44:47], v[112:115], v[12:27]
    ds_read_b128 v[68:71], v83 offset:8192
    v_mfma_f32_32x32x16_bf16 v[28:43], v[48:51], v[112:115], v[28:43]
    ds_read_b128 v[72:75], v83 offset:12288
    s_waitcnt lgkmcnt(4)
    v_mfma_f32_32x32x16_bf16 v[12:27], v[52:55], v[116:119], v[12:27]
    ds_read_b128 v[44:47], v80 offset:16384
    v_mfma_f32_32x32x16_bf16 v[28:43], v[56:59], v[116:119], v[28:43]
    ds_read_b128 v[48:51], v80 offset:20480
    s_waitcnt lgkmcnt(4)
    v_mfma_f32_32x32x16_bf16 v[12:27], v[60:63], v[120:123], v[12:27]
    ds_read_b128 v[52:55], v81 offset:16384
    v_mfma_f32_32x32x16_bf16 v[28:43], v[64:67], v[120:123], v[28:43]
    ds_read_b128 v[56:59], v81 offset:20480
    s_waitcnt lgkmcnt(4)
    v_mfma_f32_32x32x16_bf16 v[12:27], v[68:71], v[124:127], v[12:27]
    ds_read_b128 v[60:63], v82 offset:16384
    v_mfma_f32_32x32x16_bf16 v[28:43], v[72:75], v[124:127], v[28:43]
    ds_read_b128 v[64:67], v82 offset:20480
    s_waitcnt lgkmcnt(4)
    v_mfma_f32_32x32x16_bf16 v[12:27], v[44:47], v[128:131], v[12:27]
    ds_read_b128 v[68:71], v83 offset:16384
    v_mfma_f32_32x32x16_bf16 v[28:43], v[48:51], v[128:131], v[28:43]
    ds_read_b128 v[72:75], v83 offset:20480
    s_waitcnt vmcnt(0)
    s_mov_b64 exec, 1
    buffer_store_dword v94, v5, s[20:23], s51 offen sc1
    s_mov_b64 exec, -1
    s_waitcnt lgkmcnt(4)
    v_mfma_f32_32x32x16_bf16 v[12:27], v[52:55], v[132:135], v[12:27]
    ds_read_b128 v[44:47], v80 offset:24576
    v_mfma_f32_32x32x16_bf16 v[28:43], v[56:59], v[132:135], v[28:43]
    ds_read_b128 v[48:51], v80 offset:28672
    s_waitcnt lgkmcnt(4)
    v_mfma_f32_32x32x16_bf16 v[12:27], v[60:63], v[136:139], v[12:27]
    ds_read_b128 v[52:55], v81 offset:24576
    v_mfma_f32_32x32x16_bf16 v[28:43], v[64:67], v[136:139], v[28:43]
    ds_read_b128 v[56:59], v81 offset:28672
    s_waitcnt lgkmcnt(4)
    v_mfma_f32_32x32x16_bf16 v[12:27], v[68:71], v[140:143], v[12:27]
    ds_read_b128 v[60:63], v82 offset:24576
    v_mfma_f32_32x32x16_bf16 v[28:43], v[72:75], v[140:143], v[28:43]
    ds_read_b128 v[64:67], v82 offset:28672
    s_waitcnt lgkmcnt(4)
    v_mfma_f32_32x32x16_bf16 v[12:27], v[44:47], v[144:147], v[12:27]
    ds_read_b128 v[68:71], v83 offset:24576
    v_mfma_f32_32x32x16_bf16 v[28:43], v[48:51], v[144:147], v[28:43]
    ds_read_b128 v[72:75], v83 offset:28672
    s_waitcnt lgkmcnt(4)
    v_mfma_f32_32x32x16_bf16 v[12:27], v[52:55], v[148:151], v[12:27]
    s_barrier
    ds_read_b128 v[44:47], v80 offset:32768
    v_mfma_f32_32x32x16_bf16 v[28:43], v[56:59], v[148:151], v[28:43]
    ds_read_b128 v[48:51], v80 offset:36864
    s_waitcnt lgkmcnt(4)
    v_mfma_f32_32x32x16_bf16 v[12:27], v[60:63], v[152:155], v[12:27]
    ds_read_b128 v[52:55], v81 offset:32768
    v_mfma_f32_32x32x16_bf16 v[28:43], v[64:67], v[152:155], v[28:43]
    ds_read_b128 v[56:59], v81 offset:36864
    s_waitcnt lgkmcnt(4)
    v_mfma_f32_32x32x16_bf16 v[12:27], v[68:71], v[156:159], v[12:27]
    ds_read_b128 v[60:63], v82 offset:32768
    v_mfma_f32_32x32x16_bf16 v[28:43], v[72:75], v[156:159], v[28:43]
    ds_read_b128 v[64:67], v82 offset:36864
    s_waitcnt lgkmcnt(4)
    v_mfma_f32_32x32x16_bf16 v[12:27], v[44:47], v[160:163], v[12:27]
    ds_read_b128 v[68:71], v83 offset:32768
    v_mfma_f32_32x32x16_bf16 v[28:43], v[48:51], v[160:163], v[28:43]
    ds_read_b128 v[72:75], v83 offset:36864
    s_waitcnt lgkmcnt(4)
    v_mfma_f32_32x32x16_bf16 v[12:27], v[52:55], v[164:167], v[12:27]
    v_add_u32 v80, 40960, v80
    ds_read_b128 v[44:47], v80 offset:0
    v_mfma_f32_32x32x16_bf16 v[28:43], v[56:59], v[164:167], v[28:43]
    ds_read_b128 v[48:51], v80 offset:4096
    s_waitcnt lgkmcnt(4)
    v_mfma_f32_32x32x16_bf16 v[12:27], v[60:63], v[168:171], v[12:27]
    v_add_u32 v81, 40960, v81
    ds_read_b128 v[52:55], v81 offset:0
    v_mfma_f32_32x32x16_bf16 v[28:43], v[64:67], v[168:171], v[28:43]
    ds_read_b128 v[56:59], v81 offset:4096
    s_waitcnt lgkmcnt(4)
    v_mfma_f32_32x32x16_bf16 v[12:27], v[68:71], v[172:175], v[12:27]
    v_add_u32 v82, 40960, v82
    ds_read_b128 v[60:63], v82 offset:0
    v_mfma_f32_32x32x16_bf16 v[28:43], v[72:75], v[172:175], v[28:43]
    ds_read_b128 v[64:67], v82 offset:4096
    s_waitcnt lgkmcnt(4)
    v_mfma_f32_32x32x16_bf16 v[12:27], v[44:47], v[176:179], v[12:27]
    v_add_u32 v83, 40960, v83
    ds_read_b128 v[68:71], v83 offset:0
    v_mfma_f32_32x32x16_bf16 v[28:43], v[48:51], v[176:179], v[28:43]
    ds_read_b128 v[72:75], v83 offset:4096
    s_waitcnt lgkmcnt(4)
    v_mfma_f32_32x32x16_bf16 v[12:27], v[52:55], v[180:183], v[12:27]
    ds_read_b128 v[44:47], v80 offset:8192
    v_mfma_f32_32x32x16_bf16 v[28:43], v[56:59], v[180:183], v[28:43]
    ds_read_b128 v[48:51], v80 offset:12288
    s_waitcnt lgkmcnt(4)
    v_mfma_f32_32x32x16_bf16 v[12:27], v[60:63], v[184:187], v[12:27]
    ds_read_b128 v[52:55], v81 offset:8192
    v_mfma_f32_32x32x16_bf16 v[28:43], v[64:67], v[184:187], v[28:43]
    ds_read_b128 v[56:59], v81 offset:12288
    s_waitcnt lgkmcnt(4)
    v_mfma_f32_32x32x16_bf16 v[12:27], v[68:71], v[188:191], v[12:27]
    ds_read_b128 v[60:63], v82 offset:8192
    v_mfma_f32_32x32x16_bf16 v[28:43], v[72:75], v[188:191], v[28:43]
    ds_read_b128 v[64:67], v82 offset:12288
    s_waitcnt lgkmcnt(4)
    v_mfma_f32_32x32x16_bf16 v[12:27], v[44:47], v[192:195], v[12:27]
    ds_read_b128 v[68:71], v83 offset:8192
    v_mfma_f32_32x32x16_bf16 v[28:43], v[48:51], v[192:195], v[28:43]
    ds_read_b128 v[72:75], v83 offset:12288
    s_waitcnt lgkmcnt(4)
    v_mfma_f32_32x32x16_bf16 v[12:27], v[52:55], v[196:199], v[12:27]
    ds_read_b128 v[44:47], v80 offset:16384
    v_mfma_f32_32x32x16_bf16 v[28:43], v[56:59], v[196:199], v[28:43]
    ds_read_b128 v[48:51], v80 offset:20480
    s_waitcnt lgkmcnt(4)
    v_mfma_f32_32x32x16_bf16 v[12:27], v[60:63], v[200:203], v[12:27]
    ds_read_b128 v[52:55], v81 offset:16384
    v_and_b32 v2, 31, v1
    v_cmp_eq_u32 vcc, 20, v2
    v_mov_b32 v3, 0x3f803f80
    v_mfma_f32_32x32x16_bf16 v[28:43], v[64:67], v[200:203], v[28:43]
    ds_read_b128 v[56:59], v81 offset:20480
    s_waitcnt lgkmcnt(4)
    v_mfma_f32_32x32x16_bf16 v[12:27], v[68:71], v[204:207], v[12:27]
    ds_read_b128 v[60:63], v82 offset:16384
    v_cndmask_b32 v2, 0, v3, vcc
    v_mfma_f32_32x32x16_bf16 v[28:43], v[72:75], v[204:207], v[28:43]
    ds_read_b128 v[64:67], v82 offset:20480
    s_waitcnt lgkmcnt(4)
    v_mfma_f32_32x32x16_bf16 v[12:27], v[44:47], v[208:211], v[12:27]
    ds_read_b128 v[68:71], v83 offset:16384
    v_mov_b32 v176, v2
    v_mov_b32 v177, v2
    v_mov_b32 v178, v2
    v_mov_b32 v179, v2
    v_mfma_f32_32x32x16_bf16 v[28:43], v[48:51], v[208:211], v[28:43]
    ds_read_b128 v[72:75], v83 offset:20480
    s_waitcnt lgkmcnt(4)
    v_mfma_f32_32x32x16_bf16 v[12:27], v[52:55], v[212:215], v[12:27]
    ds_read_b128 v[44:47], v80 offset:24576
    v_mov_b32 v180, v2
    v_mov_b32 v181, v2
    v_mov_b32 v182, v2
    v_mov_b32 v183, v2
    v_mfma_f32_32x32x16_bf16 v[28:43], v[56:59], v[212:215], v[28:43]
    ds_read_b128 v[48:51], v80 offset:28672
    s_waitcnt lgkmcnt(4)
    v_mfma_f32_32x32x16_bf16 v[12:27], v[60:63], v[216:219], v[12:27]
    ds_read_b128 v[52:55], v81 offset:24576
    v_mov_b32 v184, v2
    v_mov_b32 v185, v2
    v_mov_b32 v186, v2
    v_mov_b32 v187, v2
    v_mfma_f32_32x32x16_bf16 v[28:43], v[64:67], v[216:219], v[28:43]
    ds_read_b128 v[56:59], v81 offset:28672
    s_waitcnt lgkmcnt(4)
    v_mfma_f32_32x32x16_bf16 v[12:27], v[68:71], v[220:223], v[12:27]
    ds_read_b128 v[60:63], v82 offset:24576
    v_mov_b32 v188, v2
    v_mov_b32 v189, v2
    v_mov_b32 v190, v2
    v_mov_b32 v191, v2
    v_mfma_f32_32x32x16_bf16 v[28:43], v[72:75], v[220:223], v[28:43]
    ds_read_b128 v[64:67], v82 offset:28672
    s_waitcnt lgkmcnt(4)
    v_mfma_f32_32x32x16_bf16 v[12:27], v[44:47], v[224:227], v[12:27]
    ds_read_b128 v[68:71], v83 offset:24576
    v_mov_b32 v96, 0
    v_mov_b32 v97, 0
    v_mov_b32 v98, 0
    v_mov_b32 v99, 0
    v_mfma_f32_32x32x16_bf16 v[28:43], v[48:51], v[224:227], v[28:43]
    ds_read_b128 v[72:75], v83 offset:28672
    s_waitcnt lgkmcnt(4)
    v_mfma_f32_32x32x16_bf16 v[12:27], v[52:55], v[228:231], v[12:27]
    ds_read_b128 v[44:47], v80 offset:32768
    v_mov_b32 v100, 0
    v_mov_b32 v101, 0
    v_mov_b32 v102, 0
    v_mov_b32 v103, 0
    v_mfma_f32_32x32x16_bf16 v[28:43], v[56:59], v[228:231], v[28:43]
    ds_read_b128 v[48:51], v80 offset:36864
    s_waitcnt lgkmcnt(4)
    v_mfma_f32_32x32x16_bf16 v[12:27], v[60:63], v[232:235], v[12:27]
    ds_read_b128 v[52:55], v81 offset:32768
    v_mov_b32 v104, 0
    v_mov_b32 v105, 0
    v_mov_b32 v106, 0
    v_mov_b32 v107, 0
    v_mfma_f32_32x32x16_bf16 v[28:43], v[64:67], v[232:235], v[28:43]
    ds_read_b128 v[56:59], v81 offset:36864
    s_waitcnt lgkmcnt(4)
    v_mfma_f32_32x32x16_bf16 v[12:27], v[68:71], v[236:239], v[12:27]
    ds_read_b128 v[60:63], v82 offset:32768
    v_mov_b32 v152, 0
    v_mov_b32 v153, 0
    v_mov_b32 v154, 0
    v_mov_b32 v155, 0
    v_mfma_f32_32x32x16_bf16 v[28:43], v[72:75], v[236:239], v[28:43]
    ds_read_b128 v[64:67], v82 offset:36864
    s_waitcnt lgkmcnt(4)
    v_mfma_f32_32x32x16_bf16 v[12:27], v[44:47], v[240:243], v[12:27]
    ds_read_b128 v[68:71], v83 offset:32768
    v_mfma_f32_32x32x16_bf16 v[28:43], v[48:51], v[240:243], v[28:43]
    ds_read_b128 v[72:75], v83 offset:36864
    s_waitcnt lgkmcnt(4)
    v_mfma_f32_32x32x16_bf16 v[12:27], v[52:55], v[244:247], v[12:27]
    v_mfma_f32_32x32x16_bf16 v[28:43], v[56:59], v[244:247], v[28:43]
    s_waitcnt lgkmcnt(2)
    v_mfma_f32_32x32x16_bf16 v[12:27], v[60:63], v[248:251], v[12:27]
    v_mfma_f32_32x32x16_bf16 v[28:43], v[64:67], v[248:251], v[28:43]
    s_waitcnt lgkmcnt(0)
    v_mfma_f32_32x32x16_bf16 v[12:27], v[68:71], v[252:255], v[12:27]
    v_mfma_f32_32x32x16_bf16 v[28:43], v[72:75], v[252:255], v[28:43]
    v_add_u32 v86, 512, v86
    s_add_u32 s51, s51, 262144
    s_add_u32 s64, s64, 1310720
    s_add_u32 s65, s65, 1310720
    s_add_u32 s66, s66, 1310720
    s_add_u32 s67, s67, 1310720
    s_call_b64 s[52:53], L_epV
    s_branch L_ae
L_epV:
    ds_read_b128 v[44:47], v86 offset:0
    ds_read_b128 v[48:51], v86 offset:32
    ds_read_b128 v[52:55], v86 offset:64
    ds_read_b128 v[56:59], v86 offset:96
    ds_read_b128 v[60:63], v86 offset:128
    ds_read_b128 v[64:67], v86 offset:160
    ds_read_b128 v[68:71], v86 offset:192
    ds_read_b128 v[72:75], v86 offset:224
    s_waitcnt lgkmcnt(0)
    s_nop 2
    v_pk_fma_f32 v[12:13], v[44:45], v[76:77], v[12:13] op_sel:[0,0,0] op_sel_hi:[1,0,1]
    v_pk_fma_f32 v[14:15], v[46:47], v[76:77], v[14:15] op_sel:[0,0,0] op_sel_hi:[1,0,1]
    v_pk_fma_f32 v[16:17], v[48:49], v[76:77], v[16:17] op_sel:[0,0,0] op_sel_hi:[1,0,1]
    v_pk_fma_f32 v[18:19], v[50:51], v[76:77], v[18:19] op_sel:[0,0,0] op_sel_hi:[1,0,1]
    v_pk_fma_f32 v[20:21], v[52:53], v[76:77], v[20:21] op_sel:[0,0,0] op_sel_hi:[1,0,1]
    v_pk_fma_f32 v[22:23], v[54:55], v[76:77], v[22:23] op_sel:[0,0,0] op_sel_hi:[1,0,1]
    v_pk_fma_f32 v[24:25], v[56:57], v[76:77], v[24:25] op_sel:[0,0,0] op_sel_hi:[1,0,1]
    v_pk_fma_f32 v[26:27], v[58:59], v[76:77], v[26:27] op_sel:[0,0,0] op_sel_hi:[1,0,1]
    ds_read_b128 v[44:47], v86 offset:256
    ds_read_b128 v[48:51], v86 offset:288
    ds_read_b128 v[52:55], v86 offset:320
    ds_read_b128 v[56:59], v86 offset:352
    v_pk_fma_f32 v[28:29], v[60:61], v[76:77], v[28:29] op_sel:[0,0,0] op_sel_hi:[1,0,1]
    v_pk_fma_f32 v[30:31], v[62:63], v[76:77], v[30:31] op_sel:[0,0,0] op_sel_hi:[1,0,1]
    v_pk_fma_f32 v[32:33], v[64:65], v[76:77], v[32:33] op_sel:[0,0,0] op_sel_hi:[1,0,1]
    v_pk_fma_f32 v[34:35], v[66:67], v[76:77], v[34:35] op_sel:[0,0,0] op_sel_hi:[1,0,1]
    v_pk_fma_f32 v[36:37], v[68:69], v[76:77], v[36:37] op_sel:[0,0,0] op_sel_hi:[1,0,1]
    v_pk_fma_f32 v[38:39], v[70:71], v[76:77], v[38:39] op_sel:[0,0,0] op_sel_hi:[1,0,1]
    v_pk_fma_f32 v[40:41], v[72:73], v[76:77], v[40:41] op_sel:[0,0,0] op_sel_hi:[1,0,1]
    v_pk_fma_f32 v[42:43], v[74:75], v[76:77], v[42:43] op_sel:[0,0,0] op_sel_hi:[1,0,1]
    ds_read_b128 v[60:63], v86 offset:384
    ds_read_b128 v[64:67], v86 offset:416
    ds_read_b128 v[68:71], v86 offset:448
    ds_read_b128 v[72:75], v86 offset:480
    s_waitcnt lgkmcnt(4)
    v_pk_mul_f32 v[12:13], v[12:13], v[44:45]
    v_pk_mul_f32 v[14:15], v[14:15], v[46:47]
    v_pk_mul_f32 v[16:17], v[16:17], v[48:49]
    v_pk_mul_f32 v[18:19], v[18:19], v[50:51]
    v_pk_mul_f32 v[20:21], v[20:21], v[52:53]
    v_pk_mul_f32 v[22:23], v[22:23], v[54:55]
    v_pk_mul_f32 v[24:25], v[24:25], v[56:57]
    v_pk_mul_f32 v[26:27], v[26:27], v[58:59]
    v_cvt_pk_bf16_f32 v44, v12, v13
    v_cvt_pk_bf16_f32 v45, v14, v15
    v_cvt_pk_bf16_f32 v46, v16, v17
    v_cvt_pk_bf16_f32 v47, v18, v19
    v_cvt_pk_bf16_f32 v48, v20, v21
    v_cvt_pk_bf16_f32 v49, v22, v23
    v_cvt_pk_bf16_f32 v50, v24, v25
    v_cvt_pk_bf16_f32 v51, v26, v27
    buffer_store_dwordx4 v[44:47], v95, s[20:23], s64 offen sc1
    buffer_store_dwordx4 v[48:51], v95, s[20:23], s65 offen sc1
    s_waitcnt lgkmcnt(0)
    v_pk_mul_f32 v[28:29], v[28:29], v[60:61]
    v_pk_mul_f32 v[30:31], v[30:31], v[62:63]
    v_pk_mul_f32 v[32:33], v[32:33], v[64:65]
    v_pk_mul_f32 v[34:35], v[34:35], v[66:67]
    v_pk_mul_f32 v[36:37], v[36:37], v[68:69]
    v_pk_mul_f32 v[38:39], v[38:39], v[70:71]
    v_pk_mul_f32 v[40:41], v[40:41], v[72:73]
    v_pk_mul_f32 v[42:43], v[42:43], v[74:75]
    v_cvt_pk_bf16_f32 v60, v28, v29
    v_cvt_pk_bf16_f32 v61, v30, v31
    v_cvt_pk_bf16_f32 v62, v32, v33
    v_cvt_pk_bf16_f32 v63, v34, v35
    v_cvt_pk_bf16_f32 v64, v36, v37
    v_cvt_pk_bf16_f32 v65, v38, v39
    v_cvt_pk_bf16_f32 v66, v40, v41
    v_cvt_pk_bf16_f32 v67, v42, v43
    buffer_store_dwordx4 v[60:63], v95, s[20:23], s66 offen sc1
    buffer_store_dwordx4 v[64:67], v95, s[20:23], s67 offen sc1
    s_nop 1
    s_setpc_b64 s[52:53]
L_ae:
    v_mov_b32 v194, v94
    v_mov_b32 v195, 0
    s_mov_b32 s43, 1094
    v_mov_b32 v4, 0
    v_pk_mov_b32 v[76:77], v[4:5], v[4:5]
    v_pk_mov_b32 v[78:79], v[4:5], v[4:5]
    v_pk_mov_b32 v[80:81], v[4:5], v[4:5]
    v_pk_mov_b32 v[82:83], v[4:5], v[4:5]
    v_pk_mov_b32 v[84:85], v[4:5], v[4:5]
    v_pk_mov_b32 v[86:87], v[4:5], v[4:5]
    v_pk_mov_b32 v[88:89], v[4:5], v[4:5]
    v_pk_mov_b32 v[90:91], v[4:5], v[4:5]
    v_pk_mov_b32 v[92:93], v[4:5], v[4:5]
    v_pk_mov_b32 v[94:95], v[4:5], v[4:5]
    s_branch L_A3
L_sx:
    v_mov_b32 v248, 0
    v_mov_b32 v249, 0
    s_waitcnt vmcnt(0)
    v_dot2c_f32_bf16 v248, v232, v88
    v_dot2c_f32_bf16 v249, v232, v232
    v_dot2c_f32_bf16 v248, v233, v88
    v_dot2c_f32_bf16 v249, v233, v233
    v_dot2c_f32_bf16 v248, v234, v88
    v_dot2c_f32_bf16 v249, v234, v234
    v_dot2c_f32_bf16 v248, v235, v88
    v_dot2c_f32_bf16 v249, v235, v235
    v_dot2c_f32_bf16 v248, v236, v88
    v_dot2c_f32_bf16 v249, v236, v236
    v_dot2c_f32_bf16 v248, v237, v88
    v_dot2c_f32_bf16 v249, v237, v237
    v_dot2c_f32_bf16 v248, v238, v88
    v_dot2c_f32_bf16 v249, v238, v238
    v_dot2c_f32_bf16 v248, v239, v88
    v_dot2c_f32_bf16 v249, v239, v239
    v_dot2c_f32_bf16 v248, v240, v88
    v_dot2c_f32_bf16 v249, v240, v240
    v_dot2c_f32_bf16 v248, v241, v88
    v_dot2c_f32_bf16 v249, v241, v241
    s_nop 2
    v_add_f32_dpp v248, v248, v248 row_shr:1 row_mask:0xf bank_mask:0xf bound_ctrl:0
    v_add_f32_dpp v249, v249, v249 row_shr:1 row_mask:0xf bank_mask:0xf bound_ctrl:0
    s_nop 0
    v_add_f32_dpp v248, v248, v248 row_shr:2 row_mask:0xf bank_mask:0xf bound_ctrl:0
    v_add_f32_dpp v249, v249, v249 row_shr:2 row_mask:0xf bank_mask:0xf bound_ctrl:0
    s_nop 0
    v_add_f32_dpp v248, v248, v248 row_shr:4 row_mask:0xf bank_mask:0xf bound_ctrl:0
    v_add_f32_dpp v249, v249, v249 row_shr:4 row_mask:0xf bank_mask:0xf bound_ctrl:0
    s_nop 0
    v_add_f32_dpp v248, v248, v248 row_shr:8 row_mask:0xf bank_mask:0xf bound_ctrl:0
    v_add_f32_dpp v249, v249, v249 row_shr:8 row_mask:0xf bank_mask:0xf bound_ctrl:0
    s_nop 0
    v_add_f32_dpp v248, v248, v248 row_bcast:15 row_mask:0xa bank_mask:0xf
    v_add_f32_dpp v249, v249, v249 row_bcast:15 row_mask:0xa bank_mask:0xf
    v_mul_f32 v244, 0xbacccccd, v248
    v_mul_f32 v249, 0x3acccccd, v249
    v_fma_f32 v249, -v244, v244, v249
    v_max_f32 v249, 0, v249
    v_add_f32 v249, 0x3727c5ac, v249
    v_rsq_f32 v246, v249
    v_lshrrev_b32 v3, 5, v1
    v_lshlrev_b32 v3, 4, v3
    s_lshl_b32 s34, s34, 4
    s_add_u32 s34, s34, 32571392
    s_waitcnt lgkmcnt(0)
    s_mul_i32 s36, s36, 0x9e3779b1
    s_add_u32 s36, s36, 0x7f4a7c15
    v_mov_b32 v245, s36
    v_mov_b32 v247, s36
    v_mov_b32 v94, s36
    v_mov_b32 v5, 0
    s_mov_b32 s10, 0x80000000
    s_mov_b32 s11, 0x80000000
    s_mov_b64 exec, s[10:11]
    buffer_store_dwordx4 v[244:247], v3, s[20:23], s34 offen sc1
    s_mov_b64 exec, -1
    s_getreg_b32 s60, hwreg(HW_REG_XCC_ID, 0, 4)
    s_cmp_lg_u32 s30, 0
    s_cbranch_scc1 L_nx
    s_xor_b32 s32, s36, s60
    v_mov_b32 v3, s32
    s_lshl_b32 s32, s29, 7
    s_lshl_b32 s33, s28, 2
    s_add_u32 s32, s32, s33
    s_add_u32 s32, s32, 32542720
    s_mov_b64 exec, 1
    buffer_store_dword v3, v5, s[20:23], s32 offen sc1
    s_mov_b64 exec, -1
L_nx:
    s_setpc_b64 s[52:53]
L_A2:
    s_call_b64 s[52:53], L_sx
    v_mov_b32 v194, 0
    v_mov_b32 v195, 0
    s_mov_b32 s43, 1093
    v_and_b32 v2, 31, v1
    v_cmp_eq_u32 vcc, 20, v2
    v_mov_b32 v3, 0x3f803f80
    v_mov_b32 v4, 0
    v_mov_b32 v5, 0
    v_cndmask_b32 v2, 0, v3, vcc
    v_pk_mov_b32 v[76:77], v[4:5], v[4:5]
    v_pk_mov_b32 v[78:79], v[4:5], v[4:5]
    v_pk_mov_b32 v[80:81], v[4:5], v[4:5]
    v_pk_mov_b32 v[82:83], v[4:5], v[4:5]
    v_pk_mov_b32 v[84:85], v[4:5], v[4:5]
    v_pk_mov_b32 v[86:87], v[4:5], v[4:5]
    v_pk_mov_b32 v[88:89], v[4:5], v[4:5]
    v_pk_mov_b32 v[90:91], v[4:5], v[4:5]
    v_pk_mov_b32 v[92:93], v[4:5], v[4:5]
    v_pk_mov_b32 v[94:95], v[4:5], v[4:5]
    v_pk_mov_b32 v[96:97], v[4:5], v[4:5]
    v_pk_mov_b32 v[98:99], v[4:5], v[4:5]
    v_pk_mov_b32 v[100:101], v[4:5], v[4:5]
    v_pk_mov_b32 v[102:103], v[4:5], v[4:5]
    v_pk_mov_b32 v[104:105], v[4:5], v[4:5]
    v_pk_mov_b32 v[106:107], v[4:5], v[4:5]
    v_pk_mov_b32 v[152:153], v[4:5], v[4:5]
    v_pk_mov_b32 v[154:155], v[4:5], v[4:5]
    v_pk_mov_b32 v[176:177], v[2:3], v[2:3] op_sel:[0,0]
    v_pk_mov_b32 v[178:179], v[2:3], v[2:3] op_sel:[0,0]
    v_pk_mov_b32 v[180:181], v[2:3], v[2:3] op_sel:[0,0]
    v_pk_mov_b32 v[182:183], v[2:3], v[2:3] op_sel:[0,0]
    v_pk_mov_b32 v[184:185], v[2:3], v[2:3] op_sel:[0,0]
    v_pk_mov_b32 v[186:187], v[2:3], v[2:3] op_sel:[0,0]
    v_pk_mov_b32 v[188:189], v[2:3], v[2:3] op_sel:[0,0]
    v_pk_mov_b32 v[190:191], v[2:3], v[2:3] op_sel:[0,0]
L_A3:
    s_lshr_b32 s33, s31, 1
    s_lshl_b32 s33, s33, 9
    s_add_u32 s33, s33, 81920
    v_lshrrev_b32 v2, 5, v1
    v_lshlrev_b32 v2, 11, v2
    v_and_b32 v3, 31, v1
    v_lshl_add_u32 v2, v3, 3, v2
    v_add_u32 v2, s33, v2
    v_add_u32 v3, s33, v7
    s_setprio 2
    s_barrier
    ds_read2_b64 v[156:159], v2 offset0:0 offset1:128
    ds_read_b64 v[164:165], v3 offset:4096
    ds_read2_b64 v[160:163], v2 offset0:32 offset1:160
    s_branch L_T0
L_bset:
    v_mov_b32 v9, v7
    v_and_b32 v2, 31, v1
    v_lshrrev_b32 v3, 5, v1
    v_lshlrev_b32 v8, 12, v3
    v_lshl_add_u32 v8, v2, 3, v8
    v_add_u32 v11, 256, v8
    v_mul_u32_u24 v3, 20, v3
    v_add_u32 v2, v2, v3
    v_lshlrev_b32 v10, 4, v2
    s_mov_b32 s44, 0x000fffff
    s_mov_b32 s45, 0x000fffff
    v_and_b32 v2, 31, v1
    v_cmp_eq_u32 vcc, 20, v2
    v_mov_b32 v3, 0x3f803f80
    v_mov_b32 v4, 0
    v_mov_b32 v5, 0
    v_cndmask_b32 v2, 0, v3, vcc
    v_pk_mov_b32 v[76:77], v[4:5], v[4:5]
    v_pk_mov_b32 v[78:79], v[4:5], v[4:5]
    v_pk_mov_b32 v[80:81], v[4:5], v[4:5]
    v_pk_mov_b32 v[82:83], v[4:5], v[4:5]
    v_pk_mov_b32 v[84:85], v[4:5], v[4:5]
    v_pk_mov_b32 v[86:87], v[4:5], v[4:5]
    v_pk_mov_b32 v[88:89], v[4:5], v[4:5]
    v_pk_mov_b32 v[90:91], v[4:5], v[4:5]
    v_pk_mov_b32 v[92:93], v[4:5], v[4:5]
    v_pk_mov_b32 v[94:95], v[4:5], v[4:5]
    v_pk_mov_b32 v[96:97], v[4:5], v[4:5]
    v_pk_mov_b32 v[98:99], v[4:5], v[4:5]
    v_pk_mov_b32 v[100:101], v[4:5], v[4:5]
    v_pk_mov_b32 v[102:103], v[4:5], v[4:5]
    v_pk_mov_b32 v[104:105], v[4:5], v[4:5]
    v_pk_mov_b32 v[106:107], v[4:5], v[4:5]
    v_pk_mov_b32 v[152:153], v[4:5], v[4:5]
    v_pk_mov_b32 v[154:155], v[4:5], v[4:5]
    v_pk_mov_b32 v[176:177], v[2:3], v[2:3] op_sel:[0,0]
    v_pk_mov_b32 v[178:179], v[2:3], v[2:3] op_sel:[0,0]
    v_pk_mov_b32 v[180:181], v[2:3], v[2:3] op_sel:[0,0]
    v_pk_mov_b32 v[182:183], v[2:3], v[2:3] op_sel:[0,0]
    v_pk_mov_b32 v[184:185], v[2:3], v[2:3] op_sel:[0,0]
    v_pk_mov_b32 v[186:187], v[2:3], v[2:3] op_sel:[0,0]
    v_pk_mov_b32 v[188:189], v[2:3], v[2:3] op_sel:[0,0]
    v_pk_mov_b32 v[190:191], v[2:3], v[2:3] op_sel:[0,0]
    s_mul_i32 s33, s3, 20
    s_add_u32 s34, s33, 19
    s_lshr_b32 s33, s33, 5
    s_lshr_b32 s34, s34, 5
    s_sub_u32 s34, s34, s33
    s_lshl_b32 s34, s34, 7
    s_lshl_b32 s33, s33, 7
    v_bfe_u32 v2, v1, 4, 1
    v_mul_u32_u24 v2, s34, v2
    v_and_b32 v3, 15, v1
    v_lshl_add_u32 v2, v3, 2, v2
    v_bfe_u32 v3, v1, 1, 1
    v_mul_u32_u24 v3, s34, v3
    v_and_b32 v4, 1, v1
    v_lshl_add_u32 v3, v4, 2, v3
    s_lshl_b32 s34, s100, 3
    v_add_u32 v3, s34, v3
    s_lshr_b32 s34, s31, 1
    s_add_u32 s34, s34, 1
    s_mul_i32 s34, s34, 2560
    v_add_u32 v2, s34, v2
    v_cmp_gt_u32 vcc, 32, v1
    s_nop 1
    v_cndmask_b32 v2, v3, v2, vcc
    v_add_lshl_u32 v34, s33, v2, 5
    s_mov_b32 s51, 32636928
    s_mul_i32 s34, s3, 10240
    s_and_b32 s71, s31, 1
    s_mul_i32 s71, s71, 20480
    s_cmp_ge_u32 s31, 2
    s_cbranch_scc1 L_fv
    v_add_u32 v38, 0, v6
    v_add_u32 v39, 2048, v6
    v_add_u32 v40, 4096, v6
    v_add_u32 v41, 6144, v6
    v_add_u32 v42, 8192, v6
    s_add_u32 s50, s34, 2621440
    s_movk_i32 s64, 2048
    s_movk_i32 s65, 1024
    s_movk_i32 s66, 1024
    s_branch L_fd
L_fv:
    v_add_u32 v4, 0, v1
    v_mul_u32_u24 v5, 3277, v4
    v_lshrrev_b32 v5, 16, v5
    v_mul_u32_u24 v5, 9920, v5
    v_lshl_add_u32 v38, v4, 4, v5
    v_add_u32 v4, 64, v1
    v_mul_u32_u24 v5, 3277, v4
    v_lshrrev_b32 v5, 16, v5
    v_mul_u32_u24 v5, 9920, v5
    v_lshl_add_u32 v39, v4, 4, v5
    v_add_u32 v4, 128, v1
    v_mul_u32_u24 v5, 3277, v4
    v_lshrrev_b32 v5, 16, v5
    v_mul_u32_u24 v5, 9920, v5
    v_lshl_add_u32 v40, v4, 4, v5
    v_add_u32 v4, 192, v1
    v_mul_u32_u24 v5, 3277, v4
    v_lshrrev_b32 v5, 16, v5
    v_mul_u32_u24 v5, 9920, v5
    v_lshl_add_u32 v41, v4, 4, v5
    v_add_u32 v4, 256, v1
    v_mul_u32_u24 v5, 3277, v4
    v_lshrrev_b32 v5, 16, v5
    v_mul_u32_u24 v5, 9920, v5
    v_lshl_add_u32 v42, v4, 4, v5
    s_mul_i32 s50, s3, 320
    s_add_u32 s50, s50, 5242880
    s_add_u32 s71, s71, 10240
    s_movk_i32 s64, 1024
    s_movk_i32 s65, 5120
    s_mov_b32 s66, 163840
L_fd:
    s_lshr_b32 s70, s100, 1
    s_mul_i32 s70, s70, 327680
    s_add_u32 s70, s70, s34
    s_and_b32 s33, s100, 1
    s_lshl_b32 s33, s33, 10
    s_add_u32 s70, s70, s33
    s_setpc_b64 s[52:53]
L_bse2:
    s_lshl_b32 s74, s2, 2
    s_add_u32 s74, s74, s31
    s_mul_i32 s33, s31, 5120
    s_add_u32 s33, s33, 122880
    v_and_b32 v2, 3, v1
    v_lshl_add_u32 v49, v2, 3, s33
    v_bfe_u32 v2, v1, 2, 2
    s_cmp_ge_u32 s74, 592
    s_cbranch_scc1 L_r1
    v_lshrrev_b32 v3, 4, v1
    v_lshl_add_u32 v2, v3, 3, v2
    v_mul_u32_u24 v2, 160, v2
    v_add_u32 v49, v49, v2
    s_cmp_ge_u32 s74, 160
    s_cbranch_scc1 L_r2
    s_load_dwordx2 s[12:13], s[0:1], 16
    s_mul_i32 s33, s74, 3277
    s_lshr_b32 s33, s33, 16
    s_mul_i32 s34, s33, 20
    s_sub_u32 s34, s74, s34
    s_mul_i32 s75, s74, 5120
    s_add_u32 s75, s75, 15728640
    s_mov_b32 s14, 819200
    s_cmp_ge_u32 s34, 16
    s_cbranch_scc1 L_r0t
    s_mul_i32 s34, s34, 40
    s_mov_b32 s10, 525332
    s_branch L_r0c
L_r0t:
    s_mul_i32 s34, s34, 160
    s_sub_u32 s34, s34, 2544
    s_mov_b32 s10, 5248040
    s_branch L_r0c
L_r2:
    s_load_dwordx2 s[12:13], s[0:1], 48
    s_sub_u32 s75, s74, 160
    s_mul_i32 s33, s75, 1214
    s_lshr_b32 s33, s33, 16
    s_mul_i32 s34, s33, 54
    s_sub_u32 s34, s75, s34
    s_mul_i32 s75, s75, 5120
    s_add_u32 s75, s75, 19136512
    s_mov_b32 s14, 2211840
    s_lshl_b32 s34, s34, 5
    s_mov_b32 s10, 525328
L_r0c:
    s_mul_i32 s78, s34, 1280
    s_mul_i32 s33, s33, 160
    s_add_u32 s78, s78, s33
    s_and_b32 s33, s10, 255
    s_bfe_u32 s34, s10, 0x80008
    s_lshr_b32 s10, s10, 16
    v_add_u32 v2, 0, v1
    v_mul_u32_u24 v3, 6554, v2
    v_lshrrev_b32 v3, 16, v3
    v_mul_u32_u24 v4, 10, v3
    v_sub_u32 v2, v2, v4
    v_and_b32 v4, 3, v3
    v_lshrrev_b32 v5, 4, v3
    v_mad_u32_u24 v4, v5, s33, v4
    v_bfe_u32 v5, v3, 3, 1
    v_mad_u32_u24 v4, v5, s34, v4
    v_bfe_u32 v5, v3, 2, 1
    v_mad_u32_u24 v4, v5, s10, v4
    v_mul_u32_u24 v4, 1280, v4
    v_lshl_add_u32 v44, v2, 4, v4
    v_add_u32 v2, 64, v1
    v_mul_u32_u24 v3, 6554, v2
    v_lshrrev_b32 v3, 16, v3
    v_mul_u32_u24 v4, 10, v3
    v_sub_u32 v2, v2, v4
    v_and_b32 v4, 3, v3
    v_lshrrev_b32 v5, 4, v3
    v_mad_u32_u24 v4, v5, s33, v4
    v_bfe_u32 v5, v3, 3, 1
    v_mad_u32_u24 v4, v5, s34, v4
    v_bfe_u32 v5, v3, 2, 1
    v_mad_u32_u24 v4, v5, s10, v4
    v_mul_u32_u24 v4, 1280, v4
    v_lshl_add_u32 v45, v2, 4, v4
    v_add_u32 v2, 128, v1
    v_mul_u32_u24 v3, 6554, v2
    v_lshrrev_b32 v3, 16, v3
    v_mul_u32_u24 v4, 10, v3
    v_sub_u32 v2, v2, v4
    v_and_b32 v4, 3, v3
    v_lshrrev_b32 v5, 4, v3
    v_mad_u32_u24 v4, v5, s33, v4
    v_bfe_u32 v5, v3, 3, 1
    v_mad_u32_u24 v4, v5, s34, v4
    v_bfe_u32 v5, v3, 2, 1
    v_mad_u32_u24 v4, v5, s10, v4
    v_mul_u32_u24 v4, 1280, v4
    v_lshl_add_u32 v46, v2, 4, v4
    v_add_u32 v2, 192, v1
    v_mul_u32_u24 v3, 6554, v2
    v_lshrrev_b32 v3, 16, v3
    v_mul_u32_u24 v4, 10, v3
    v_sub_u32 v2, v2, v4
    v_and_b32 v4, 3, v3
    v_lshrrev_b32 v5, 4, v3
    v_mad_u32_u24 v4, v5, s33, v4
    v_bfe_u32 v5, v3, 3, 1
    v_mad_u32_u24 v4, v5, s34, v4
    v_bfe_u32 v5, v3, 2, 1
    v_mad_u32_u24 v4, v5, s10, v4
    v_mul_u32_u24 v4, 1280, v4
    v_lshl_add_u32 v47, v2, 4, v4
    v_add_u32 v2, 256, v1
    v_mul_u32_u24 v3, 6554, v2
    v_lshrrev_b32 v3, 16, v3
    v_mul_u32_u24 v4, 10, v3
    v_sub_u32 v2, v2, v4
    v_and_b32 v4, 3, v3
    v_lshrrev_b32 v5, 4, v3
    v_mad_u32_u24 v4, v5, s33, v4
    v_bfe_u32 v5, v3, 3, 1
    v_mad_u32_u24 v4, v5, s34, v4
    v_bfe_u32 v5, v3, 2, 1
    v_mad_u32_u24 v4, v5, s10, v4
    v_mul_u32_u24 v4, 1280, v4
    v_lshl_add_u32 v48, v2, 4, v4
    s_branch L_rgo
L_r1:
    s_load_dwordx2 s[12:13], s[0:1], 32
    s_sub_u32 s75, s74, 592
    s_lshr_b32 s33, s75, 3
    s_and_b32 s34, s75, 7
    s_mul_i32 s78, s34, 276480
    s_lshl_b32 s33, s33, 6
    s_add_u32 s78, s78, s33
    s_mul_i32 s75, s75, 5120
    s_add_u32 s75, s75, 16777216
    s_mov_b32 s14, 2211840
    v_lshrrev_b32 v3, 5, v1
    v_lshl_add_u32 v2, v3, 3, v2
    v_lshl_add_u32 v49, v2, 6, v49
    v_bfe_u32 v3, v1, 4, 1
    v_lshl_add_u32 v49, v3, 5, v49
    v_lshrrev_b32 v2, 2, v1
    v_mul_u32_u24 v2, 3456, v2
    v_and_b32 v3, 3, v1
    v_lshl_add_u32 v44, v3, 4, v2
    v_add_u32 v45, 55296, v44
    v_add_u32 v46, 110592, v44
    v_add_u32 v47, 165888, v44
    v_add_u32 v48, 221184, v44
L_rgo:
    s_mov_b32 s15, 0x00020000
    s_waitcnt lgkmcnt(0)
    s_setpc_b64 s[52:53]
L_fsub:
    s_and_b32 s33, s31, 1
    s_add_u32 s33, s33, s100
    s_and_b32 s34, s32, 2
    s_add_u32 s33, s33, s34
    s_and_b32 s33, s33, 3
    s_and_b32 s34, s32, 4
    s_add_u32 s33, s33, s34
    s_mul_i32 s33, s33, 327680
    s_add_u32 s33, s33, s50
    s_and_b32 s34, s32, 1
    s_mul_i32 s62, s34, s66
    s_add_u32 s33, s33, s62
    s_mul_i32 s34, s34, s65
    s_lshr_b32 s62, s32, 1
    s_mul_i32 s62, s62, 40960
    s_add_u32 s34, s34, s62
    s_add_u32 m0, s34, s71
    s_add_u32 s32, s32, 1
    buffer_load_dwordx4 v38, s[20:23], s33 offen sc1 lds
    s_add_u32 m0, m0, s64
    s_nop 0
    buffer_load_dwordx4 v39, s[20:23], s33 offen sc1 lds
    s_add_u32 m0, m0, s64
    s_nop 0
    buffer_load_dwordx4 v40, s[20:23], s33 offen sc1 lds
    s_add_u32 m0, m0, s64
    s_nop 0
    buffer_load_dwordx4 v41, s[20:23], s33 offen sc1 lds
    s_add_u32 m0, m0, s64
    s_nop 0
    buffer_load_dwordx4 v42, s[20:23], s33 offen sc1 lds
    s_setpc_b64 s[52:53]
L_B2:
    s_setprio 3
    s_mov_b32 s10, -1
    s_mov_b32 s11, 0xf
    s_mov_b32 s42, 0
    s_mov_b64 exec, s[10:11]
L_pa:
    s_sleep 8
    buffer_load_dword v5, v34, s[20:23], s51 offen sc1
    s_add_u32 s42, s42, 1
    s_cmp_gt_u32 s42, 0x100000
    s_cbranch_scc1 L_pax
    s_waitcnt vmcnt(0)
    v_cmp_eq_u32 vcc, s36, v5
    s_cmp_eq_u64 vcc, exec
    s_cbranch_scc0 L_pa
L_pax:
    s_mov_b64 exec, -1
    s_lshl_b32 s33, s31, 10
    s_add_u32 m0, s33, 81920
    s_lshl_b32 s33, s31, 11
    s_add_u32 s33, s33, s70
    buffer_load_dwordx4 v6, s[20:23], s33 offen sc1 lds
    s_cmp_lg_u32 s31, 0
    s_cbranch_scc1 L_nq
    s_mov_b32 m0, 86016
    s_add_u32 s33, s70, 8192
    buffer_load_dwordx4 v6, s[20:23], s33 offen sc1 lds
L_nq:
    s_mov_b32 s32, 0
    s_call_b64 s[52:53], L_fsub
    s_call_b64 s[52:53], L_fsub
    s_waitcnt vmcnt(5)
    s_barrier
    s_call_b64 s[52:53], L_fsub
    s_call_b64 s[52:53], L_fsub
    s_setprio 0
    s_add_u32 s51, s51, 262144
    s_mul_i32 s33, s31, 5120
    s_add_u32 m0, s33, 122880
    s_nop 0
    buffer_load_dwordx4 v44, s[12:15], s78 offen lds
    s_add_u32 m0, m0, 1024
    s_nop 0
    buffer_load_dwordx4 v45, s[12:15], s78 offen lds
    s_add_u32 m0, m0, 1024
    s_nop 0
    buffer_load_dwordx4 v46, s[12:15], s78 offen lds
    s_add_u32 m0, m0, 1024
    s_nop 0
    buffer_load_dwordx4 v47, s[12:15], s78 offen lds
    s_add_u32 m0, m0, 1024
    s_nop 0
    buffer_load_dwordx4 v48, s[12:15], s78 offen lds
    s_add_u32 m0, m0, 1024
    s_nop 0
    s_waitcnt vmcnt(15)
    s_barrier
    s_waitcnt vmcnt(5)
    s_barrier
    s_mov_b32 s42, 0
    s_mov_b64 exec, s[10:11]
    s_branch L_pbn
L_pb:
    s_setprio 0
    s_sleep 4
L_pbn:
    s_setprio 0
    buffer_load_dword v5, v34, s[20:23], s51 offen sc1
    s_add_u32 s42, s42, 1
    s_cmp_gt_u32 s42, 0x100000
    s_cbranch_scc1 L_pbx
    s_waitcnt vmcnt(0)
    s_setprio 3
    v_cmp_eq_u32 vcc, s36, v5
    s_setprio 0
    s_cmp_eq_u64 vcc, exec
    s_cbranch_scc0 L_pb
L_pbx:
    s_setprio 0
    s_mov_b64 exec, -1
    s_call_b64 s[52:53], L_fsub
    s_call_b64 s[52:53], L_fsub
    s_setprio 0
    s_cmp_ge_u32 s74, 592
    s_cbranch_scc1 L_t1
    ds_read_b64_tr_b16 v[232:233], v49 offset:0
    ds_read_b64_tr_b16 v[234:235], v49 offset:640
    ds_read_b64_tr_b16 v[236:237], v49 offset:32
    ds_read_b64_tr_b16 v[238:239], v49 offset:672
    ds_read_b64_tr_b16 v[240:241], v49 offset:64
    ds_read_b64_tr_b16 v[242:243], v49 offset:704
    ds_read_b64_tr_b16 v[244:245], v49 offset:96
    ds_read_b64_tr_b16 v[246:247], v49 offset:736
    ds_read_b64_tr_b16 v[248:249], v49 offset:128
    ds_read_b64_tr_b16 v[250:251], v49 offset:768
    s_branch L_t2
L_t1:
    s_setprio 0
    ds_read_b64_tr_b16 v[232:233], v49 offset:0
    ds_read_b64_tr_b16 v[234:235], v49 offset:256
    ds_read_b64_tr_b16 v[236:237], v49 offset:1024
    ds_read_b64_tr_b16 v[238:239], v49 offset:1280
    ds_read_b64_tr_b16 v[240:241], v49 offset:2048
    ds_read_b64_tr_b16 v[242:243], v49 offset:2304
    ds_read_b64_tr_b16 v[244:245], v49 offset:3072
    ds_read_b64_tr_b16 v[246:247], v49 offset:3328
    ds_read_b64_tr_b16 v[248:249], v49 offset:4096
    ds_read_b64_tr_b16 v[250:251], v49 offset:4352
L_t2:
    s_setprio 0
    s_waitcnt lgkmcnt(0)
    s_add_u32 s33, s75, 4096
    buffer_store_dwordx4 v[232:235], v6, s[20:23], s75 offen offset:0 sc1
    buffer_store_dwordx4 v[236:239], v6, s[20:23], s75 offen offset:1024 sc1
    buffer_store_dwordx4 v[240:243], v6, s[20:23], s75 offen offset:2048 sc1
    buffer_store_dwordx4 v[244:247], v6, s[20:23], s75 offen offset:3072 sc1
    buffer_store_dwordx4 v[248:251], v6, s[20:23], s33 offen offset:0 sc1
    s_cmp_lt_u32 s74, 592
    s_cbranch_scc1 L_rnc
    s_setprio 3
    v_mov_b32 v4, 0x3f803f80
    v_mov_b32 v5, 0x3f803f80
    v_lshlrev_b32 v3, 2, v1
    s_setprio 0
    s_nop 0
    v_mfma_f32_4x4x4_16b_bf16 v[52:55], v[4:5], v[232:233], 0
    s_nop 1
    v_mfma_f32_4x4x4_16b_bf16 v[52:55], v[4:5], v[234:235], v[52:55]
    s_nop 1
    v_mfma_f32_4x4x4_16b_bf16 v[52:55], v[4:5], v[236:237], v[52:55]
    s_nop 1
    v_mfma_f32_4x4x4_16b_bf16 v[52:55], v[4:5], v[238:239], v[52:55]
    s_nop 1
    v_mfma_f32_4x4x4_16b_bf16 v[52:55], v[4:5], v[240:241], v[52:55]
    s_nop 1
    v_mfma_f32_4x4x4_16b_bf16 v[52:55], v[4:5], v[242:243], v[52:55]
    s_nop 1
    v_mfma_f32_4x4x4_16b_bf16 v[52:55], v[4:5], v[244:245], v[52:55]
    s_nop 1
    v_mfma_f32_4x4x4_16b_bf16 v[52:55], v[4:5], v[246:247], v[52:55]
    s_nop 1
    v_mfma_f32_4x4x4_16b_bf16 v[52:55], v[4:5], v[248:249], v[52:55]
    s_nop 1
    v_mfma_f32_4x4x4_16b_bf16 v[52:55], v[4:5], v[250:251], v[52:55]
    s_nop 1
    s_sub_u32 s62, s74, 592
    s_lshl_b32 s62, s62, 7
    s_add_u32 s62, s62, 33161216
    s_setprio 3
    v_permlane32_swap_b32 v52, v53
    v_add_f32 v2, v52, v53
    s_setprio 0
    s_mov_b64 exec, 0xffffffff
    buffer_store_dword v2, v3, s[20:23], s62 offen sc1
    s_mov_b64 exec, -1
L_rnc:
    s_setprio 3
    v_mov_b32 v4, 0
    v_mov_b32 v5, s36
    s_setprio 0
    s_lshl_b32 s74, s74, 2
    s_add_u32 s74, s74, 32538624
    s_waitcnt vmcnt(5)
    s_barrier
    s_waitcnt vmcnt(0)
    s_mov_b64 exec, 1
    buffer_store_dword v5, v4, s[20:23], s74 offen sc1
    s_mov_b64 exec, -1
    s_call_b64 s[52:53], L_fsub
    s_call_b64 s[52:53], L_fsub
    s_setprio 0
    s_lshr_b32 s33, s31, 1
    s_lshl_b32 s33, s33, 9
    s_add_u32 s33, s33, s70
    s_add_u32 s33, s33, 1310720
    s_add_u32 s34, s33, 8192
    buffer_load_dwordx2 v[156:157], v8, s[20:23], s33 offen offset:0 sc1
    buffer_load_dwordx2 v[158:159], v8, s[20:23], s33 offen offset:2048 sc1
    buffer_load_dwordx2 v[160:161], v8, s[20:23], s33 offen offset:256 sc1
    buffer_load_dwordx2 v[162:163], v8, s[20:23], s33 offen offset:2304 sc1
    buffer_load_dwordx2 v[164:165], v7, s[20:23], s34 offen sc1
    s_waitcnt vmcnt(0)
    s_call_b64 s[52:53], L_vf
    s_cmp_eq_u32 s72, 0
    s_cbranch_scc1 L_ntc
    s_setprio 3
    v_lshlrev_b32 v2, 7, v1
    s_setprio 0
    s_lshl_b32 s32, s29, 7
    s_lshl_b32 s33, s28, 2
    s_add_u32 s32, s32, s33
    s_add_u32 s32, s32, s31
    s_mul_i32 s33, s32, 1280
    s_add_u32 s33, s33, 21495808
    s_mov_b32 s10, 4294967295
    s_mov_b32 s11, 4294967295
    s_mov_b64 exec, s[10:11]
    s_setprio 3
    v_add_u32 v3, s33, v2
    s_setprio 0
    s_mul_i32 s33, s32, 1280
    s_add_u32 s33, s33, 22805248
    s_mov_b32 s10, 4294966272
    s_mov_b32 s11, 4294967295
    s_mov_b64 exec, s[10:11]
    s_setprio 3
    v_add_u32 v3, s33, v2
    s_setprio 0
    s_mul_i32 s33, s32, 128
    s_add_u32 s33, s33, 24114688
    s_mov_b32 s10, 4293918720
    s_mov_b32 s11, 4294967295
    s_mov_b64 exec, s[10:11]
    s_setprio 3
    v_add_u32 v3, s33, v2
    s_setprio 0
    s_mul_i32 s33, s32, 128
    s_add_u32 s33, s33, 24245632
    s_mov_b32 s10, 4292870144
    s_mov_b32 s11, 4294967295
    s_mov_b64 exec, s[10:11]
    s_setprio 3
    v_add_u32 v3, s33, v2
    s_setprio 0
    s_lshl_b32 s33, s29, 2
    s_add_u32 s33, s33, s31
    s_lshl_b32 s33, s33, 10
    s_add_u32 s33, s33, 32601344
    s_mov_b32 s10, 4290772992
    s_mov_b32 s11, 4294967295
    s_mov_b64 exec, s[10:11]
    s_setprio 3
    v_add_u32 v3, s33, v2
    s_setprio 0
    s_mov_b32 s10, 1073741823
    s_mov_b32 s11, 0
    s_mov_b64 exec, s[10:11]
    buffer_load_dword v170, v3, s[20:23], 0 offen sc1
    s_mov_b64 exec, -1
L_ntc:
    s_setprio 0
    s_barrier
    s_add_u32 s34, s76, 8192
    buffer_load_dwordx4 v[192:195], v6, s[20:23], s34 offen offset:1024 sc1
    s_add_u32 s34, s76, 8192
    buffer_load_dwordx4 v[196:199], v6, s[20:23], s34 offen offset:2048 sc1
    s_add_u32 s34, s76, 8192
    buffer_load_dwordx4 v[200:203], v6, s[20:23], s34 offen offset:3072 sc1
    s_add_u32 s34, s76, 12288
    buffer_load_dwordx4 v[204:207], v6, s[20:23], s34 offen offset:0 sc1
    s_add_u32 s34, s76, 12288
    buffer_load_dwordx4 v[208:211], v6, s[20:23], s34 offen offset:1024 sc1
    s_add_u32 s34, s76, 12288
    buffer_load_dwordx4 v[212:215], v6, s[20:23], s34 offen offset:2048 sc1
    s_add_u32 s34, s76, 12288
    buffer_load_dwordx4 v[216:219], v6, s[20:23], s34 offen offset:3072 sc1
    s_add_u32 s34, s76, 16384
    buffer_load_dwordx4 v[220:223], v6, s[20:23], s34 offen offset:0 sc1
    s_add_u32 s34, s76, 16384
    buffer_load_dwordx4 v[224:227], v6, s[20:23], s34 offen offset:1024 sc1
    s_add_u32 s34, s76, 16384
    buffer_load_dwordx4 v[228:231], v6, s[20:23], s34 offen offset:2048 sc1
    s_add_u32 s34, s76, 16384
    buffer_load_dwordx4 v[232:235], v6, s[20:23], s34 offen offset:3072 sc1
    s_add_u32 s34, s77, 0
    buffer_load_dwordx4 v[236:239], v6, s[20:23], s34 offen offset:0 sc1
    s_add_u32 s34, s77, 0
    buffer_load_dwordx4 v[240:243], v6, s[20:23], s34 offen offset:1024 sc1
    s_add_u32 s34, s77, 0
    buffer_load_dwordx4 v[244:247], v6, s[20:23], s34 offen offset:2048 sc1
    s_add_u32 s34, s77, 0
    buffer_load_dwordx4 v[248:251], v6, s[20:23], s34 offen offset:3072 sc1
    s_add_u32 s34, s77, 4096
    buffer_load_dwordx4 v[252:255], v6, s[20:23], s34 offen offset:0 sc1
    s_setprio 3
    v_lshlrev_b32 v2, 7, v1
    s_setprio 0
    s_mul_i32 s32, s56, 10240
    s_add_u32 s32, s32, s37
    s_add_u32 s32, s32, 0
    s_add_u32 s33, s32, 8192
    buffer_load_dword v0, v2, s[20:23], s32 offen sc1
    s_mov_b64 exec, 65535
    buffer_load_dword v0, v2, s[20:23], s33 offen sc1
    s_mov_b64 exec, -1
    s_setprio 3
    v_lshlrev_b32 v2, 7, v1
    s_setprio 0
    s_mul_i32 s32, s56, 10240
    s_add_u32 s32, s32, s39
    s_add_u32 s32, s32, 0
    s_add_u32 s33, s32, 8192
    buffer_load_dword v0, v2, s[20:23], s32 offen sc1
    s_mov_b64 exec, 65535
    buffer_load_dword v0, v2, s[20:23], s33 offen sc1
    s_mov_b64 exec, -1
    s_mov_b32 s43, 5137
    s_setprio 1
L_T0:
    s_and_b32 s32, s31, 1
    s_mul_i32 s32, s32, 20480
    v_add_u32 v8, s32, v8
    v_add_u32 v11, s32, v11
    v_add_u32 v9, s32, v9
    v_add_u32 v10, s32, v10
    ds_read2st64_b64 v[172:175], v8 offset0:0 offset1:4
    ds_read_b64 v[166:167], v9 offset:8192
    s_mov_b64 exec, s[44:45]
    ds_read_b128 v[176:179], v10 offset:10240
    ds_read_b128 v[180:183], v10 offset:10880
    s_mov_b64 exec, -1
    s_waitcnt lgkmcnt(2)
    v_mfma_f32_32x32x16_bf16 v[12:27], v[172:175], v[156:159], 0
    v_mfma_f32_32x32x16_bf16 v[28:43], v[172:175], v[160:163], 0
    ds_read2st64_b64 v[172:175], v11 offset0:0 offset1:4
    s_nop 8
    v_mfma_f32_32x32x4_2b_bf16 v[12:43], v[166:167], v[164:165], v[12:43] cbsz:1 abid:0
    v_mov_b32 v74, 0
    v_mov_b32 v75, 0
    s_mov_b32 s35, 4
    s_nop 15
    s_nop 0
    v_max3_f32 v140, v12, v13, v14
    v_max3_f32 v142, v28, v29, v30
    v_max3_f32 v140, v140, v15, v16
    v_max3_f32 v142, v142, v31, v32
    v_max3_f32 v140, v140, v17, v18
    v_max3_f32 v142, v142, v33, v34
    v_max3_f32 v140, v140, v19, v20
    v_max3_f32 v142, v142, v35, v36
    v_max3_f32 v140, v140, v21, v22
    v_max3_f32 v142, v142, v37, v38
    v_max3_f32 v140, v140, v23, v24
    v_max3_f32 v142, v142, v39, v40
    v_max3_f32 v140, v140, v25, v26
    v_max3_f32 v142, v142, v41, v42
    v_max_f32 v140, v140, v27
    v_max_f32 v142, v142, v43
    v_mov_b32 v141, v140
    v_mov_b32 v143, v142
    s_nop 0
    v_permlane32_swap_b32 v140, v141
    v_permlane32_swap_b32 v142, v143
    v_max_f32 v140, v140, v141
    v_max_f32 v142, v142, v143
    v_sub_f32 v140, 0, v140
    v_sub_f32 v142, 0, v142
    s_cmp_lt_u32 s30, 4
    s_cbranch_scc1 L_tA
    s_setprio 1
L_tA:
    v_pk_mov_b32 v[108:109], v[140:141], v[140:141] op_sel:[0,0]
    v_pk_mov_b32 v[110:111], v[140:141], v[140:141] op_sel:[0,0]
    v_pk_mov_b32 v[112:113], v[140:141], v[140:141] op_sel:[0,0]
    v_pk_mov_b32 v[114:115], v[140:141], v[140:141] op_sel:[0,0]
    v_pk_mov_b32 v[116:117], v[140:141], v[140:141] op_sel:[0,0]
    v_pk_mov_b32 v[118:119], v[140:141], v[140:141] op_sel:[0,0]
    v_pk_mov_b32 v[120:121], v[140:141], v[140:141] op_sel:[0,0]
    v_pk_mov_b32 v[122:123], v[140:141], v[140:141] op_sel:[0,0]
    v_pk_mov_b32 v[124:125], v[142:143], v[142:143] op_sel:[0,0]
    v_pk_mov_b32 v[126:127], v[142:143], v[142:143] op_sel:[0,0]
    v_pk_mov_b32 v[128:129], v[142:143], v[142:143] op_sel:[0,0]
    v_pk_mov_b32 v[130:131], v[142:143], v[142:143] op_sel:[0,0]
    v_pk_mov_b32 v[132:133], v[142:143], v[142:143] op_sel:[0,0]
    v_pk_mov_b32 v[134:135], v[142:143], v[142:143] op_sel:[0,0]
    v_pk_mov_b32 v[136:137], v[142:143], v[142:143] op_sel:[0,0]
    v_pk_mov_b32 v[138:139], v[142:143], v[142:143] op_sel:[0,0]
    v_pk_add_f32 v[12:13], v[12:13], v[108:109]
    v_pk_add_f32 v[14:15], v[14:15], v[108:109]
    v_pk_add_f32 v[16:17], v[16:17], v[108:109]
    v_pk_add_f32 v[18:19], v[18:19], v[108:109]
    v_pk_add_f32 v[20:21], v[20:21], v[108:109]
    v_pk_add_f32 v[22:23], v[22:23], v[108:109]
    v_pk_add_f32 v[24:25], v[24:25], v[108:109]
    v_pk_add_f32 v[26:27], v[26:27], v[108:109]
    v_pk_add_f32 v[28:29], v[28:29], v[124:125]
    v_pk_add_f32 v[30:31], v[30:31], v[124:125]
    v_pk_add_f32 v[32:33], v[32:33], v[124:125]
    v_pk_add_f32 v[34:35], v[34:35], v[124:125]
    v_pk_add_f32 v[36:37], v[36:37], v[124:125]
    v_pk_add_f32 v[38:39], v[38:39], v[124:125]
    v_pk_add_f32 v[40:41], v[40:41], v[124:125]
    v_pk_add_f32 v[42:43], v[42:43], v[124:125]
.p2align 6
L_loop:
    v_exp_f32 v12, v12
    v_cvt_pk_bf16_f32 v155, v74, v75
    v_exp_f32 v13, v13
    v_exp_f32 v14, v14
    v_mfma_f32_32x32x16_bf16 v[92:107], v[188:191], v[152:155], v[92:107]
    s_waitcnt lgkmcnt(0)
    v_cvt_pk_bf16_f32 v140, v12, v13
    v_exp_f32 v15, v15
    v_exp_f32 v16, v16
    v_cvt_pk_bf16_f32 v141, v14, v15
    v_exp_f32 v17, v17
    v_mfma_f32_32x32x16_bf16 v[44:59], v[172:175], v[156:159], v[108:123]
    s_bitcmp0_b32 s43, 1
    v_exp_f32 v18, v18
    v_cvt_pk_bf16_f32 v142, v16, v17
    v_exp_f32 v19, v19
    v_exp_f32 v20, v20
    v_cvt_pk_bf16_f32 v143, v18, v19
    v_mfma_f32_32x32x16_bf16 v[60:75], v[172:175], v[160:163], v[124:139]
    ds_read2st64_b64 v[172:175], v8 offset0:1 offset1:5
    v_exp_f32 v21, v21
    v_exp_f32 v22, v22
    v_cvt_pk_bf16_f32 v144, v20, v21
    v_exp_f32 v23, v23
    v_exp_f32 v24, v24
    v_mfma_f32_32x32x16_bf16 v[76:91], v[176:179], v[140:143], v[76:91]
    s_mov_b64 exec, s[44:45]
    ds_read_b128 v[184:187], v10 offset:11520
    ds_read_b128 v[188:191], v10 offset:12160
    s_mov_b64 exec, -1
    v_cvt_pk_bf16_f32 v145, v22, v23
    v_exp_f32 v25, v25
    v_exp_f32 v26, v26
    v_cvt_pk_bf16_f32 v146, v24, v25
    v_exp_f32 v27, v27
    v_exp_f32 v28, v28
    v_mfma_f32_32x32x4_2b_bf16 v[44:75], v[166:167], v[164:165], v[44:75] cbsz:1 abid:1
    v_cvt_pk_bf16_f32 v147, v26, v27
    v_exp_f32 v29, v29
    v_exp_f32 v30, v30
    v_cvt_pk_bf16_f32 v148, v28, v29
    v_exp_f32 v31, v31
    v_exp_f32 v32, v32
    v_cvt_pk_bf16_f32 v149, v30, v31
    v_exp_f32 v33, v33
    v_exp_f32 v34, v34
    v_cvt_pk_bf16_f32 v150, v32, v33
    v_mfma_f32_32x32x16_bf16 v[76:91], v[180:183], v[144:147], v[76:91]
    ds_read_b64 v[168:169], v9 offset:8704
    v_exp_f32 v35, v35
    v_exp_f32 v36, v36
    v_cvt_pk_bf16_f32 v151, v34, v35
    v_exp_f32 v37, v37
    v_exp_f32 v38, v38
    v_cvt_pk_bf16_f32 v152, v36, v37
    v_exp_f32 v39, v39
    v_mfma_f32_32x32x16_bf16 v[92:107], v[176:179], v[148:151], v[92:107]
    s_cbranch_scc1 L_fb3
    s_waitcnt vmcnt(0)
    s_mov_b64 exec, 1
    buffer_store_dword v194, v195, s[20:23], s51 offen sc1
    s_mov_b64 exec, -1
L_fb3:
    v_exp_f32 v40, v40
    v_cvt_pk_bf16_f32 v153, v38, v39
    v_exp_f32 v41, v41
    v_exp_f32 v42, v42
    v_cvt_pk_bf16_f32 v154, v40, v41
    v_exp_f32 v43, v43
    v_exp_f32 v44, v44
    v_cvt_pk_bf16_f32 v155, v42, v43
    v_exp_f32 v45, v45
    v_exp_f32 v46, v46
    v_mfma_f32_32x32x16_bf16 v[92:107], v[180:183], v[152:155], v[92:107]
    s_waitcnt lgkmcnt(0)
    v_cvt_pk_bf16_f32 v140, v44, v45
    v_exp_f32 v47, v47
    v_exp_f32 v48, v48
    v_cvt_pk_bf16_f32 v141, v46, v47
    v_exp_f32 v49, v49
    v_mfma_f32_32x32x16_bf16 v[12:27], v[172:175], v[156:159], v[108:123]
    v_exp_f32 v50, v50
    v_cvt_pk_bf16_f32 v142, v48, v49
    v_exp_f32 v51, v51
    v_exp_f32 v52, v52
    v_cvt_pk_bf16_f32 v143, v50, v51
    v_mfma_f32_32x32x16_bf16 v[28:43], v[172:175], v[160:163], v[124:139]
    ds_read2st64_b64 v[172:175], v11 offset0:1 offset1:5
    v_exp_f32 v53, v53
    v_exp_f32 v54, v54
    v_cvt_pk_bf16_f32 v144, v52, v53
    v_exp_f32 v55, v55
    v_exp_f32 v56, v56
    v_mfma_f32_32x32x16_bf16 v[76:91], v[184:187], v[140:143], v[76:91]
    s_mov_b64 exec, s[44:45]
    ds_read_b128 v[176:179], v10 offset:12800
    ds_read_b128 v[180:183], v10 offset:13440
    s_mov_b64 exec, -1
    v_cvt_pk_bf16_f32 v145, v54, v55
    v_exp_f32 v57, v57
    v_exp_f32 v58, v58
    v_cvt_pk_bf16_f32 v146, v56, v57
    v_exp_f32 v59, v59
    v_exp_f32 v60, v60
    v_mfma_f32_32x32x4_2b_bf16 v[12:43], v[168:169], v[164:165], v[12:43] cbsz:1 abid:0
    v_cvt_pk_bf16_f32 v147, v58, v59
    v_exp_f32 v61, v61
    v_exp_f32 v62, v62
    v_cvt_pk_bf16_f32 v148, v60, v61
    v_exp_f32 v63, v63
    v_exp_f32 v64, v64
    v_cvt_pk_bf16_f32 v149, v62, v63
    v_exp_f32 v65, v65
    v_exp_f32 v66, v66
    v_cvt_pk_bf16_f32 v150, v64, v65
    v_mfma_f32_32x32x16_bf16 v[76:91], v[188:191], v[144:147], v[76:91]
    v_exp_f32 v67, v67
    v_exp_f32 v68, v68
    v_cvt_pk_bf16_f32 v151, v66, v67
    v_exp_f32 v69, v69
    v_exp_f32 v70, v70
    v_cvt_pk_bf16_f32 v152, v68, v69
    v_exp_f32 v71, v71
    v_mfma_f32_32x32x16_bf16 v[92:107], v[184:187], v[148:151], v[92:107]
    v_exp_f32 v72, v72
    v_cvt_pk_bf16_f32 v153, v70, v71
    v_exp_f32 v73, v73
    v_exp_f32 v74, v74
    v_cvt_pk_bf16_f32 v154, v72, v73
    v_exp_f32 v75, v75
    v_exp_f32 v12, v12
    v_cvt_pk_bf16_f32 v155, v74, v75
    v_exp_f32 v13, v13
    v_exp_f32 v14, v14
    v_mfma_f32_32x32x16_bf16 v[92:107], v[188:191], v[152:155], v[92:107]
    s_waitcnt lgkmcnt(0)
    v_cvt_pk_bf16_f32 v140, v12, v13
    v_exp_f32 v15, v15
    v_exp_f32 v16, v16
    v_cvt_pk_bf16_f32 v141, v14, v15
    v_exp_f32 v17, v17
    v_mfma_f32_32x32x16_bf16 v[44:59], v[172:175], v[156:159], v[108:123]
    s_and_b32 s32, s43, 3
    v_exp_f32 v18, v18
    v_cvt_pk_bf16_f32 v142, v16, v17
    v_exp_f32 v19, v19
    v_exp_f32 v20, v20
    v_cvt_pk_bf16_f32 v143, v18, v19
    v_mfma_f32_32x32x16_bf16 v[60:75], v[172:175], v[160:163], v[124:139]
    s_cbranch_scc0 L_ne2
    s_barrier
L_ne2:
    ds_read2st64_b64 v[172:175], v8 offset0:2 offset1:6
    v_exp_f32 v21, v21
    v_exp_f32 v22, v22
    v_cvt_pk_bf16_f32 v144, v20, v21
    v_exp_f32 v23, v23
    v_exp_f32 v24, v24
    v_mfma_f32_32x32x16_bf16 v[76:91], v[176:179], v[140:143], v[76:91]
    s_mov_b64 exec, s[44:45]
    ds_read_b128 v[184:187], v10 offset:14080
    ds_read_b128 v[188:191], v10 offset:14720
    s_mov_b64 exec, -1
    v_cvt_pk_bf16_f32 v145, v22, v23
    v_exp_f32 v25, v25
    v_exp_f32 v26, v26
    v_cvt_pk_bf16_f32 v146, v24, v25
    v_exp_f32 v27, v27
    v_exp_f32 v28, v28
    v_mfma_f32_32x32x4_2b_bf16 v[44:75], v[168:169], v[164:165], v[44:75] cbsz:1 abid:1
    v_cvt_pk_bf16_f32 v147, v26, v27
    v_exp_f32 v29, v29
    v_exp_f32 v30, v30
    v_cvt_pk_bf16_f32 v148, v28, v29
    v_exp_f32 v31, v31
    v_exp_f32 v32, v32
    v_cvt_pk_bf16_f32 v149, v30, v31
    v_exp_f32 v33, v33
    v_exp_f32 v34, v34
    v_cvt_pk_bf16_f32 v150, v32, v33
    v_mfma_f32_32x32x16_bf16 v[76:91], v[180:183], v[144:147], v[76:91]
    ds_read_b64 v[166:167], v9 offset:9216
    v_exp_f32 v35, v35
    v_exp_f32 v36, v36
    v_cvt_pk_bf16_f32 v151, v34, v35
    v_exp_f32 v37, v37
    v_exp_f32 v38, v38
    v_cvt_pk_bf16_f32 v152, v36, v37
    v_exp_f32 v39, v39
    v_mfma_f32_32x32x16_bf16 v[92:107], v[176:179], v[148:151], v[92:107]
    s_lshr_b32 s43, s43, 2
    v_exp_f32 v40, v40
    v_cvt_pk_bf16_f32 v153, v38, v39
    v_exp_f32 v41, v41
    v_exp_f32 v42, v42
    v_cvt_pk_bf16_f32 v154, v40, v41
    v_exp_f32 v43, v43
    v_exp_f32 v44, v44
    v_cvt_pk_bf16_f32 v155, v42, v43
    v_exp_f32 v45, v45
    v_exp_f32 v46, v46
    v_mfma_f32_32x32x16_bf16 v[92:107], v[180:183], v[152:155], v[92:107]
    s_waitcnt lgkmcnt(0)
    v_cvt_pk_bf16_f32 v140, v44, v45
    v_exp_f32 v47, v47
    v_exp_f32 v48, v48
    v_cvt_pk_bf16_f32 v141, v46, v47
    v_exp_f32 v49, v49
    v_mfma_f32_32x32x16_bf16 v[12:27], v[172:175], v[156:159], v[108:123]
    v_exp_f32 v50, v50
    v_cvt_pk_bf16_f32 v142, v48, v49
    v_exp_f32 v51, v51
    v_exp_f32 v52, v52
    v_cvt_pk_bf16_f32 v143, v50, v51
    v_mfma_f32_32x32x16_bf16 v[28:43], v[172:175], v[160:163], v[124:139]
    ds_read2st64_b64 v[172:175], v11 offset0:2 offset1:6
    v_exp_f32 v53, v53
    v_exp_f32 v54, v54
    v_cvt_pk_bf16_f32 v144, v52, v53
    v_exp_f32 v55, v55
    v_exp_f32 v56, v56
    v_mfma_f32_32x32x16_bf16 v[76:91], v[184:187], v[140:143], v[76:91]
    s_mov_b64 exec, s[44:45]
    ds_read_b128 v[176:179], v10 offset:15360
    ds_read_b128 v[180:183], v10 offset:16000
    s_mov_b64 exec, -1
    v_cvt_pk_bf16_f32 v145, v54, v55
    v_exp_f32 v57, v57
    v_exp_f32 v58, v58
    v_cvt_pk_bf16_f32 v146, v56, v57
    v_exp_f32 v59, v59
    v_exp_f32 v60, v60
    v_mfma_f32_32x32x4_2b_bf16 v[12:43], v[166:167], v[164:165], v[12:43] cbsz:1 abid:0
    v_cvt_pk_bf16_f32 v147, v58, v59
    v_exp_f32 v61, v61
    v_exp_f32 v62, v62
    v_cvt_pk_bf16_f32 v148, v60, v61
    v_exp_f32 v63, v63
    v_exp_f32 v64, v64
    v_cvt_pk_bf16_f32 v149, v62, v63
    v_exp_f32 v65, v65
    v_exp_f32 v66, v66
    v_cvt_pk_bf16_f32 v150, v64, v65
    v_mfma_f32_32x32x16_bf16 v[76:91], v[188:191], v[144:147], v[76:91]
    v_exp_f32 v67, v67
    v_exp_f32 v68, v68
    v_cvt_pk_bf16_f32 v151, v66, v67
    v_exp_f32 v69, v69
    v_exp_f32 v70, v70
    v_cvt_pk_bf16_f32 v152, v68, v69
    v_exp_f32 v71, v71
    v_mfma_f32_32x32x16_bf16 v[92:107], v[184:187], v[148:151], v[92:107]
    v_exp_f32 v72, v72
    v_cvt_pk_bf16_f32 v153, v70, v71
    v_exp_f32 v73, v73
    v_exp_f32 v74, v74
    v_cvt_pk_bf16_f32 v154, v72, v73
    v_exp_f32 v75, v75
    v_exp_f32 v12, v12
    v_cvt_pk_bf16_f32 v155, v74, v75
    v_exp_f32 v13, v13
    v_exp_f32 v14, v14
    v_mfma_f32_32x32x16_bf16 v[92:107], v[188:191], v[152:155], v[92:107]
    s_waitcnt lgkmcnt(0)
    v_cvt_pk_bf16_f32 v140, v12, v13
    v_exp_f32 v15, v15
    v_exp_f32 v16, v16
    v_cvt_pk_bf16_f32 v141, v14, v15
    v_exp_f32 v17, v17
    v_mfma_f32_32x32x16_bf16 v[44:59], v[172:175], v[156:159], v[108:123]
    v_exp_f32 v18, v18
    v_cvt_pk_bf16_f32 v142, v16, v17
    v_exp_f32 v19, v19
    v_exp_f32 v20, v20
    v_cvt_pk_bf16_f32 v143, v18, v19
    v_mfma_f32_32x32x16_bf16 v[60:75], v[172:175], v[160:163], v[124:139]
    ds_read2st64_b64 v[172:175], v8 offset0:3 offset1:7
    v_exp_f32 v21, v21
    v_exp_f32 v22, v22
    v_cvt_pk_bf16_f32 v144, v20, v21
    v_exp_f32 v23, v23
    v_exp_f32 v24, v24
    v_mfma_f32_32x32x16_bf16 v[76:91], v[176:179], v[140:143], v[76:91]
    s_mov_b64 exec, s[44:45]
    ds_read_b128 v[184:187], v10 offset:16640
    ds_read_b128 v[188:191], v10 offset:17280
    s_mov_b64 exec, -1
    v_cvt_pk_bf16_f32 v145, v22, v23
    v_exp_f32 v25, v25
    v_exp_f32 v26, v26
    v_cvt_pk_bf16_f32 v146, v24, v25
    v_exp_f32 v27, v27
    v_exp_f32 v28, v28
    v_mfma_f32_32x32x4_2b_bf16 v[44:75], v[166:167], v[164:165], v[44:75] cbsz:1 abid:1
    v_cvt_pk_bf16_f32 v147, v26, v27
    v_exp_f32 v29, v29
    v_exp_f32 v30, v30
    v_cvt_pk_bf16_f32 v148, v28, v29
    v_exp_f32 v31, v31
    v_exp_f32 v32, v32
    v_cvt_pk_bf16_f32 v149, v30, v31
    v_exp_f32 v33, v33
    v_exp_f32 v34, v34
    v_cvt_pk_bf16_f32 v150, v32, v33
    v_mfma_f32_32x32x16_bf16 v[76:91], v[180:183], v[144:147], v[76:91]
    ds_read_b64 v[168:169], v9 offset:9728
    v_exp_f32 v35, v35
    v_exp_f32 v36, v36
    v_cvt_pk_bf16_f32 v151, v34, v35
    v_exp_f32 v37, v37
    v_exp_f32 v38, v38
    v_cvt_pk_bf16_f32 v152, v36, v37
    v_exp_f32 v39, v39
    v_mfma_f32_32x32x16_bf16 v[92:107], v[176:179], v[148:151], v[92:107]
    v_exp_f32 v40, v40
    v_cvt_pk_bf16_f32 v153, v38, v39
    v_exp_f32 v41, v41
    v_exp_f32 v42, v42
    v_cvt_pk_bf16_f32 v154, v40, v41
    v_exp_f32 v43, v43
    v_exp_f32 v44, v44
    v_cvt_pk_bf16_f32 v155, v42, v43
    v_exp_f32 v45, v45
    v_exp_f32 v46, v46
    v_mfma_f32_32x32x16_bf16 v[92:107], v[180:183], v[152:155], v[92:107]
    s_waitcnt lgkmcnt(0)
    v_cvt_pk_bf16_f32 v140, v44, v45
    v_exp_f32 v47, v47
    v_exp_f32 v48, v48
    v_cvt_pk_bf16_f32 v141, v46, v47
    v_exp_f32 v49, v49
    v_mfma_f32_32x32x16_bf16 v[12:27], v[172:175], v[156:159], v[108:123]
    v_exp_f32 v50, v50
    v_cvt_pk_bf16_f32 v142, v48, v49
    v_exp_f32 v51, v51
    v_exp_f32 v52, v52
    v_cvt_pk_bf16_f32 v143, v50, v51
    v_mfma_f32_32x32x16_bf16 v[28:43], v[172:175], v[160:163], v[124:139]
    ds_read2st64_b64 v[172:175], v11 offset0:3 offset1:7
    v_exp_f32 v53, v53
    v_exp_f32 v54, v54
    v_cvt_pk_bf16_f32 v144, v52, v53
    v_exp_f32 v55, v55
    v_exp_f32 v56, v56
    v_mfma_f32_32x32x16_bf16 v[76:91], v[184:187], v[140:143], v[76:91]
    s_mov_b64 exec, s[44:45]
    ds_read_b128 v[176:179], v10 offset:17920
    ds_read_b128 v[180:183], v10 offset:18560
    s_mov_b64 exec, -1
    v_cvt_pk_bf16_f32 v145, v54, v55
    v_exp_f32 v57, v57
    v_exp_f32 v58, v58
    v_cvt_pk_bf16_f32 v146, v56, v57
    v_exp_f32 v59, v59
    v_exp_f32 v60, v60
    v_mfma_f32_32x32x4_2b_bf16 v[12:43], v[168:169], v[164:165], v[12:43] cbsz:1 abid:0
    v_cvt_pk_bf16_f32 v147, v58, v59
    v_exp_f32 v61, v61
    v_exp_f32 v62, v62
    v_cvt_pk_bf16_f32 v148, v60, v61
    v_exp_f32 v63, v63
    v_exp_f32 v64, v64
    v_cvt_pk_bf16_f32 v149, v62, v63
    v_exp_f32 v65, v65
    v_exp_f32 v66, v66
    v_cvt_pk_bf16_f32 v150, v64, v65
    v_mfma_f32_32x32x16_bf16 v[76:91], v[188:191], v[144:147], v[76:91]
    v_exp_f32 v67, v67
    v_exp_f32 v68, v68
    v_cvt_pk_bf16_f32 v151, v66, v67
    v_exp_f32 v69, v69
    v_exp_f32 v70, v70
    v_cvt_pk_bf16_f32 v152, v68, v69
    v_exp_f32 v71, v71
    v_mfma_f32_32x32x16_bf16 v[92:107], v[184:187], v[148:151], v[92:107]
    v_exp_f32 v72, v72
    v_cvt_pk_bf16_f32 v153, v70, v71
    v_exp_f32 v73, v73
    v_exp_f32 v74, v74
    v_cvt_pk_bf16_f32 v154, v72, v73
    v_exp_f32 v75, v75
    v_exp_f32 v12, v12
    v_cvt_pk_bf16_f32 v155, v74, v75
    v_exp_f32 v13, v13
    v_exp_f32 v14, v14
    v_mfma_f32_32x32x16_bf16 v[92:107], v[188:191], v[152:155], v[92:107]
    s_waitcnt lgkmcnt(0)
    v_cvt_pk_bf16_f32 v140, v12, v13
    v_exp_f32 v15, v15
    v_exp_f32 v16, v16
    v_cvt_pk_bf16_f32 v141, v14, v15
    v_exp_f32 v17, v17
    v_mfma_f32_32x32x16_bf16 v[44:59], v[172:175], v[156:159], v[108:123]
    s_and_b32 s32, s43, 3
    v_exp_f32 v18, v18
    v_cvt_pk_bf16_f32 v142, v16, v17
    v_exp_f32 v19, v19
    v_exp_f32 v20, v20
    v_cvt_pk_bf16_f32 v143, v18, v19
    v_mfma_f32_32x32x16_bf16 v[60:75], v[172:175], v[160:163], v[124:139]
    s_cbranch_scc0 L_ne6
    s_barrier
L_ne6:
    ds_read2st64_b64 v[172:175], v8 offset0:80 offset1:84
    v_exp_f32 v21, v21
    v_exp_f32 v22, v22
    v_cvt_pk_bf16_f32 v144, v20, v21
    v_exp_f32 v23, v23
    v_exp_f32 v24, v24
    v_mfma_f32_32x32x16_bf16 v[76:91], v[176:179], v[140:143], v[76:91]
    s_mov_b64 exec, s[44:45]
    ds_read_b128 v[184:187], v10 offset:19200
    ds_read_b128 v[188:191], v10 offset:19840
    s_mov_b64 exec, -1
    v_cvt_pk_bf16_f32 v145, v22, v23
    v_exp_f32 v25, v25
    v_exp_f32 v26, v26
    v_cvt_pk_bf16_f32 v146, v24, v25
    v_exp_f32 v27, v27
    v_exp_f32 v28, v28
    v_mfma_f32_32x32x4_2b_bf16 v[44:75], v[168:169], v[164:165], v[44:75] cbsz:1 abid:1
    v_cvt_pk_bf16_f32 v147, v26, v27
    v_exp_f32 v29, v29
    v_exp_f32 v30, v30
    v_cvt_pk_bf16_f32 v148, v28, v29
    v_exp_f32 v31, v31
    v_exp_f32 v32, v32
    v_cvt_pk_bf16_f32 v149, v30, v31
    v_exp_f32 v33, v33
    v_exp_f32 v34, v34
    v_cvt_pk_bf16_f32 v150, v32, v33
    v_mfma_f32_32x32x16_bf16 v[76:91], v[180:183], v[144:147], v[76:91]
    ds_read_b64 v[166:167], v9 offset:49152
    v_exp_f32 v35, v35
    v_exp_f32 v36, v36
    v_cvt_pk_bf16_f32 v151, v34, v35
    v_exp_f32 v37, v37
    v_exp_f32 v38, v38
    v_cvt_pk_bf16_f32 v152, v36, v37
    v_exp_f32 v39, v39
    v_mfma_f32_32x32x16_bf16 v[92:107], v[176:179], v[148:151], v[92:107]
    s_lshr_b32 s43, s43, 2
    v_exp_f32 v40, v40
    v_cvt_pk_bf16_f32 v153, v38, v39
    v_exp_f32 v41, v41
    v_exp_f32 v42, v42
    v_cvt_pk_bf16_f32 v154, v40, v41
    v_exp_f32 v43, v43
    v_exp_f32 v44, v44
    v_cvt_pk_bf16_f32 v155, v42, v43
    v_exp_f32 v45, v45
    v_exp_f32 v46, v46
    v_mfma_f32_32x32x16_bf16 v[92:107], v[180:183], v[152:155], v[92:107]
    s_waitcnt lgkmcnt(0)
    v_cvt_pk_bf16_f32 v140, v44, v45
    v_exp_f32 v47, v47
    v_exp_f32 v48, v48
    v_cvt_pk_bf16_f32 v141, v46, v47
    v_exp_f32 v49, v49
    v_mfma_f32_32x32x16_bf16 v[12:27], v[172:175], v[156:159], v[108:123]
    s_sub_u32 s35, s35, 1
    v_exp_f32 v50, v50
    v_cvt_pk_bf16_f32 v142, v48, v49
    v_exp_f32 v51, v51
    v_exp_f32 v52, v52
    v_cvt_pk_bf16_f32 v143, v50, v51
    v_mfma_f32_32x32x16_bf16 v[28:43], v[172:175], v[160:163], v[124:139]
    ds_read2st64_b64 v[172:175], v11 offset0:80 offset1:84
    v_exp_f32 v53, v53
    v_exp_f32 v54, v54
    v_cvt_pk_bf16_f32 v144, v52, v53
    v_exp_f32 v55, v55
    v_exp_f32 v56, v56
    v_mfma_f32_32x32x16_bf16 v[76:91], v[184:187], v[140:143], v[76:91]
    s_mov_b64 exec, s[44:45]
    ds_read_b128 v[176:179], v10 offset:51200
    ds_read_b128 v[180:183], v10 offset:51840
    s_mov_b64 exec, -1
    v_cvt_pk_bf16_f32 v145, v54, v55
    v_exp_f32 v57, v57
    v_exp_f32 v58, v58
    v_cvt_pk_bf16_f32 v146, v56, v57
    v_exp_f32 v59, v59
    v_exp_f32 v60, v60
    v_mfma_f32_32x32x4_2b_bf16 v[12:43], v[166:167], v[164:165], v[12:43] cbsz:1 abid:0
    v_cvt_pk_bf16_f32 v147, v58, v59
    v_exp_f32 v61, v61
    v_exp_f32 v62, v62
    v_cvt_pk_bf16_f32 v148, v60, v61
    v_exp_f32 v63, v63
    v_exp_f32 v64, v64
    v_cvt_pk_bf16_f32 v149, v62, v63
    v_exp_f32 v65, v65
    v_exp_f32 v66, v66
    v_cvt_pk_bf16_f32 v150, v64, v65
    v_mfma_f32_32x32x16_bf16 v[76:91], v[188:191], v[144:147], v[76:91]
    v_exp_f32 v67, v67
    v_exp_f32 v68, v68
    v_cvt_pk_bf16_f32 v151, v66, v67
    v_exp_f32 v69, v69
    v_exp_f32 v70, v70
    v_cvt_pk_bf16_f32 v152, v68, v69
    v_exp_f32 v71, v71
    v_mfma_f32_32x32x16_bf16 v[92:107], v[184:187], v[148:151], v[92:107]
    s_cmp_lg_u32 s35, 0
    v_exp_f32 v72, v72
    v_cvt_pk_bf16_f32 v153, v70, v71
    v_exp_f32 v73, v73
    v_exp_f32 v74, v74
    v_cvt_pk_bf16_f32 v154, v72, v73
    v_exp_f32 v75, v75
    v_add_u32 v8, 40960, v8
    v_add_u32 v11, 40960, v11
    v_add_u32 v9, 40960, v9
    v_add_u32 v10, 40960, v10
    s_cbranch_scc1 L_loop
    v_cvt_pk_bf16_f32 v155, v74, v75
    s_waitcnt lgkmcnt(0)
    s_nop 0
    v_mfma_f32_32x32x16_bf16 v[92:107], v[188:191], v[152:155], v[92:107]
    v_add_f32 v2, |v76|, |v77|
    v_add_f32 v3, |v78|, |v79|
    v_add_f32 v2, v2, |v80|
    v_add_f32 v3, v3, |v81|
    v_add_f32 v2, v2, |v82|
    v_add_f32 v3, v3, |v83|
    v_add_f32 v2, v2, |v84|
    v_add_f32 v3, v3, |v85|
    v_add_f32 v2, v2, |v86|
    v_add_f32 v3, v3, |v87|
    s_nop 1
    v_add_f32 v2, v2, |v92|
    v_add_f32 v3, v3, |v93|
    v_add_f32 v2, v2, |v94|
    v_add_f32 v3, v3, |v95|
    v_add_f32 v2, v2, |v96|
    v_add_f32 v3, v3, |v97|
    v_add_f32 v2, v2, |v98|
    v_add_f32 v3, v3, |v99|
    v_add_f32 v2, v2, |v100|
    v_add_f32 v3, v3, |v101|
    v_add_f32 v2, v2, |v102|
    v_add_f32 v3, v3, |v103|
    v_add_f32 v2, v2, v3
    v_mov_b32 v3, 0x71800000
    v_cmp_lt_f32 vcc, v2, v3
    s_cmp_eq_u64 vcc, exec
    s_cbranch_scc1 L_safe
    s_call_b64 s[52:53], L_slow
L_safe:
    s_cmp_ge_u32 s30, 4
    s_cbranch_scc1 L_Bend
    s_mul_i32 s50, s31, 10240
    s_xor_b32 s32, s31, 1
    s_mul_i32 s78, s32, 10240
    s_mov_b32 s54, 0
    s_movk_i32 s59, 2048
    s_barrier
    s_call_b64 s[52:53], L_cw
    s_call_b64 s[52:53], L_vf
    s_setprio 2
    s_add_u32 s34, s76, 0
    buffer_load_dwordx4 v[156:159], v6, s[20:23], s34 offen offset:0 sc1
    s_add_u32 s34, s76, 0
    buffer_load_dwordx4 v[160:163], v6, s[20:23], s34 offen offset:1024 sc1
    s_add_u32 s34, s76, 0
    buffer_load_dwordx4 v[164:167], v6, s[20:23], s34 offen offset:2048 sc1
    s_add_u32 s34, s76, 0
    buffer_load_dwordx4 v[168:171], v6, s[20:23], s34 offen offset:3072 sc1
    s_add_u32 s34, s76, 4096
    buffer_load_dwordx4 v[172:175], v6, s[20:23], s34 offen offset:0 sc1
    s_add_u32 s34, s76, 4096
    buffer_load_dwordx4 v[176:179], v6, s[20:23], s34 offen offset:1024 sc1
    s_add_u32 s34, s76, 4096
    buffer_load_dwordx4 v[180:183], v6, s[20:23], s34 offen offset:2048 sc1
    s_add_u32 s34, s76, 4096
    buffer_load_dwordx4 v[184:187], v6, s[20:23], s34 offen offset:3072 sc1
    s_add_u32 s34, s76, 8192
    buffer_load_dwordx4 v[188:191], v6, s[20:23], s34 offen offset:0 sc1
    s_add_u32 s34, s76, 8192
    buffer_load_dwordx4 v[192:195], v6, s[20:23], s34 offen offset:1024 sc1
    s_add_u32 s34, s76, 8192
    buffer_load_dwordx4 v[196:199], v6, s[20:23], s34 offen offset:2048 sc1
    s_add_u32 s34, s76, 8192
    buffer_load_dwordx4 v[200:203], v6, s[20:23], s34 offen offset:3072 sc1
    s_add_u32 s34, s76, 12288
    buffer_load_dwordx4 v[204:207], v6, s[20:23], s34 offen offset:0 sc1
    s_add_u32 s34, s76, 12288
    buffer_load_dwordx4 v[208:211], v6, s[20:23], s34 offen offset:1024 sc1
    s_add_u32 s34, s76, 12288
    buffer_load_dwordx4 v[212:215], v6, s[20:23], s34 offen offset:2048 sc1
    s_add_u32 s34, s76, 12288
    buffer_load_dwordx4 v[216:219], v6, s[20:23], s34 offen offset:3072 sc1
    s_add_u32 s34, s76, 16384
    buffer_load_dwordx4 v[220:223], v6, s[20:23], s34 offen offset:0 sc1
    s_add_u32 s34, s76, 16384
    buffer_load_dwordx4 v[224:227], v6, s[20:23], s34 offen offset:1024 sc1
    s_add_u32 s34, s76, 16384
    buffer_load_dwordx4 v[228:231], v6, s[20:23], s34 offen offset:2048 sc1
    s_add_u32 s34, s76, 16384
    buffer_load_dwordx4 v[232:235], v6, s[20:23], s34 offen offset:3072 sc1
    s_add_u32 s34, s77, 0
    buffer_load_dwordx4 v[236:239], v6, s[20:23], s34 offen offset:0 sc1
    s_add_u32 s34, s77, 0
    buffer_load_dwordx4 v[240:243], v6, s[20:23], s34 offen offset:1024 sc1
    s_add_u32 s34, s77, 0
    buffer_load_dwordx4 v[244:247], v6, s[20:23], s34 offen offset:2048 sc1
    s_add_u32 s34, s77, 0
    buffer_load_dwordx4 v[248:251], v6, s[20:23], s34 offen offset:3072 sc1
    s_add_u32 s34, s77, 4096
    buffer_load_dwordx4 v[252:255], v6, s[20:23], s34 offen offset:0 sc1
    s_waitcnt lgkmcnt(0)
    s_barrier
    s_call_b64 s[52:53], L_cf
    s_add_u32 s34, s39, 0
    buffer_load_dwordx4 v[96:99], v6, s[20:23], s34 offen offset:0 sc1
    s_add_u32 s34, s39, 0
    buffer_load_dwordx4 v[100:103], v6, s[20:23], s34 offen offset:1024 sc1
    s_add_u32 s34, s39, 0
    buffer_load_dwordx4 v[104:107], v6, s[20:23], s34 offen offset:2048 sc1
    s_add_u32 s34, s39, 0
    buffer_load_dwordx4 v[108:111], v6, s[20:23], s34 offen offset:3072 sc1
    s_add_u32 s34, s39, 4096
    buffer_load_dwordx4 v[112:115], v6, s[20:23], s34 offen offset:0 sc1
    s_add_u32 s34, s39, 4096
    buffer_load_dwordx4 v[116:119], v6, s[20:23], s34 offen offset:1024 sc1
    s_add_u32 s34, s39, 4096
    buffer_load_dwordx4 v[120:123], v6, s[20:23], s34 offen offset:2048 sc1
    s_add_u32 s34, s39, 4096
    buffer_load_dwordx4 v[124:127], v6, s[20:23], s34 offen offset:3072 sc1
    s_add_u32 s34, s39, 8192
    buffer_load_dwordx4 v[128:131], v6, s[20:23], s34 offen offset:0 sc1
    s_add_u32 s34, s39, 8192
    buffer_load_dwordx4 v[132:135], v6, s[20:23], s34 offen offset:1024 sc1
    s_add_u32 s34, s39, 8192
    buffer_load_dwordx4 v[136:139], v6, s[20:23], s34 offen offset:2048 sc1
    s_add_u32 s34, s39, 8192
    buffer_load_dwordx4 v[140:143], v6, s[20:23], s34 offen offset:3072 sc1
    s_add_u32 s34, s39, 12288
    buffer_load_dwordx4 v[144:147], v6, s[20:23], s34 offen offset:0 sc1
    s_add_u32 s34, s39, 12288
    buffer_load_dwordx4 v[148:151], v6, s[20:23], s34 offen offset:1024 sc1
    s_add_u32 s34, s39, 12288
    buffer_load_dwordx4 v[152:155], v6, s[20:23], s34 offen offset:2048 sc1
    s_call_b64 s[52:53], L_wo
    s_setprio 2
    s_add_u32 s34, s39, 12288
    buffer_load_dwordx4 v[156:159], v6, s[20:23], s34 offen offset:3072 sc1
    s_add_u32 s34, s39, 16384
    buffer_load_dwordx4 v[160:163], v6, s[20:23], s34 offen offset:0 sc1
    s_add_u32 s34, s39, 16384
    buffer_load_dwordx4 v[164:167], v6, s[20:23], s34 offen offset:1024 sc1
    s_add_u32 s34, s39, 16384
    buffer_load_dwordx4 v[168:171], v6, s[20:23], s34 offen offset:2048 sc1
    s_add_u32 s34, s39, 16384
    buffer_load_dwordx4 v[172:175], v6, s[20:23], s34 offen offset:3072 sc1
    s_add_u32 s34, s39, 20480
    buffer_load_dwordx4 v[176:179], v6, s[20:23], s34 offen offset:0 sc1
    s_add_u32 s34, s39, 20480
    buffer_load_dwordx4 v[180:183], v6, s[20:23], s34 offen offset:1024 sc1
    s_add_u32 s34, s39, 20480
    buffer_load_dwordx4 v[184:187], v6, s[20:23], s34 offen offset:2048 sc1
    s_add_u32 s34, s39, 20480
    buffer_load_dwordx4 v[188:191], v6, s[20:23], s34 offen offset:3072 sc1
    s_add_u32 s34, s39, 24576
    buffer_load_dwordx4 v[192:195], v6, s[20:23], s34 offen offset:0 sc1
    s_add_u32 s34, s39, 24576
    buffer_load_dwordx4 v[196:199], v6, s[20:23], s34 offen offset:1024 sc1
    s_add_u32 s34, s39, 24576
    buffer_load_dwordx4 v[200:203], v6, s[20:23], s34 offen offset:2048 sc1
    s_add_u32 s34, s39, 24576
    buffer_load_dwordx4 v[204:207], v6, s[20:23], s34 offen offset:3072 sc1
    s_add_u32 s34, s39, 28672
    buffer_load_dwordx4 v[208:211], v6, s[20:23], s34 offen offset:0 sc1
    s_add_u32 s34, s39, 28672
    buffer_load_dwordx4 v[212:215], v6, s[20:23], s34 offen offset:1024 sc1
    s_add_u32 s34, s39, 28672
    buffer_load_dwordx4 v[216:219], v6, s[20:23], s34 offen offset:2048 sc1
    s_add_u32 s34, s39, 28672
    buffer_load_dwordx4 v[220:223], v6, s[20:23], s34 offen offset:3072 sc1
    s_add_u32 s34, s39, 32768
    buffer_load_dwordx4 v[224:227], v6, s[20:23], s34 offen offset:0 sc1
    s_add_u32 s34, s39, 32768
    buffer_load_dwordx4 v[228:231], v6, s[20:23], s34 offen offset:1024 sc1
    s_add_u32 s34, s39, 32768
    buffer_load_dwordx4 v[232:235], v6, s[20:23], s34 offen offset:2048 sc1
    s_add_u32 s34, s39, 32768
    buffer_load_dwordx4 v[236:239], v6, s[20:23], s34 offen offset:3072 sc1
    s_add_u32 s34, s39, 36864
    buffer_load_dwordx4 v[240:243], v6, s[20:23], s34 offen offset:0 sc1
    s_add_u32 s34, s39, 36864
    buffer_load_dwordx4 v[244:247], v6, s[20:23], s34 offen offset:1024 sc1
    s_add_u32 s34, s39, 36864
    buffer_load_dwordx4 v[248:251], v6, s[20:23], s34 offen offset:2048 sc1
    s_add_u32 s34, s39, 36864
    buffer_load_dwordx4 v[252:255], v6, s[20:23], s34 offen offset:3072 sc1
    s_waitcnt lgkmcnt(0)
    s_barrier
    s_call_b64 s[52:53], L_rw
    v_lshrrev_b32 v2, 5, v1
    v_lshlrev_b32 v2, 9, v2
    v_and_b32 v3, 31, v1
    v_lshl_add_u32 v2, v3, 2, v2
    v_lshlrev_b32 v3, 1, v3
    s_lshl_b32 s32, s58, 10
    s_add_u32 s32, s32, 33161216
    s_lshl_b32 s33, s58, 6
    buffer_load_dword v12, v2, s[20:23], s32 offen offset:0 sc1
    buffer_load_dword v13, v2, s[20:23], s32 offen offset:128 sc1
    buffer_load_dword v14, v2, s[20:23], s32 offen offset:256 sc1
    buffer_load_dword v15, v2, s[20:23], s32 offen offset:384 sc1
    buffer_load_ushort v20, v3, s[16:19], s33 offen
    s_lshl_b32 s32, s40, 10
    s_add_u32 s32, s32, 33161216
    s_lshl_b32 s33, s40, 6
    buffer_load_dword v16, v2, s[20:23], s32 offen offset:0 sc1
    buffer_load_dword v17, v2, s[20:23], s32 offen offset:128 sc1
    buffer_load_dword v18, v2, s[20:23], s32 offen offset:256 sc1
    buffer_load_dword v19, v2, s[20:23], s32 offen offset:384 sc1
    buffer_load_ushort v21, v3, s[16:19], s33 offen
    v_and_b32 v2, 15, v1
    v_mul_u32_u24 v2, 1280, v2
    v_lshrrev_b32 v3, 4, v1
    v_mul_u32_u24 v3, 48, v3
    v_add_u32 v2, v2, v3
    s_lshl_b32 s32, s69, 5
    s_sub_u32 s32, s74, s32
    s_add_u32 s32, s32, 1310720
    buffer_load_dword v0, v2, s[12:15], s32 offen
    s_mul_i32 s32, s31, 8192
    s_add_u32 s32, s32, 40960
    s_add_u32 m0, s32, 0
    s_add_u32 s34, s41, 10240
    buffer_load_dwordx4 v6, s[20:23], s34 offen offset:0 sc1 lds
    buffer_load_dwordx4 v6, s[20:23], s34 offen offset:1024 sc1 lds
    buffer_load_dwordx4 v6, s[20:23], s34 offen offset:2048 sc1 lds
    buffer_load_dwordx4 v6, s[20:23], s34 offen offset:3072 sc1 lds
    s_add_u32 m0, s32, 4096
    s_add_u32 s34, s41, 14336
    buffer_load_dwordx4 v6, s[20:23], s34 offen offset:0 sc1 lds
    buffer_load_dwordx4 v6, s[20:23], s34 offen offset:1024 sc1 lds
    buffer_load_dwordx4 v6, s[20:23], s34 offen offset:2048 sc1 lds
    buffer_load_dwordx4 v6, s[20:23], s34 offen offset:3072 sc1 lds
    s_barrier
    s_mov_b32 s55, 0
    s_mov_b32 s59, 0
    s_call_b64 s[52:53], L_hs
    s_cmp_lg_u32 s30, 3
    s_cbranch_scc1 L_nst
    s_call_b64 s[52:53], L_st
L_nst:
    v_add_f32 v12, v12, v13
    v_add_f32 v14, v14, v15
    v_add_f32 v12, v12, v14
    v_mov_b32 v13, v12
    v_lshlrev_b32 v20, 16, v20
    v_add_f32 v16, v16, v17
    v_add_f32 v18, v18, v19
    v_add_f32 v16, v16, v18
    v_mov_b32 v17, v16
    v_lshlrev_b32 v21, 16, v21
    s_lshl_b32 s32, s31, 8
    s_add_u32 s32, s32, 106496
    v_and_b32 v2, 31, v1
    v_lshl_add_u32 v2, v2, 2, s32
    v_permlane32_swap_b32 v12, v13
    v_add_f32 v12, v12, v13
    ds_write_b32 v2, v12 offset:0
    ds_write_b32 v2, v20 offset:128
    v_permlane32_swap_b32 v16, v17
    v_add_f32 v16, v16, v17
    ds_write_b32 v2, v16 offset:1024
    ds_write_b32 v2, v21 offset:1152
    v_mov_b32 v2, 109056
    v_mov_b32 v3, 0
    ds_write_b32 v2, v3
    s_waitcnt vmcnt(0)
    s_add_u32 s32, s31, 4
    s_cmp_ge_u32 s32, s57
    s_cbranch_scc1 L_ns
    s_mul_i32 s32, s31, 8192
    s_add_u32 s32, s32, 81920
    s_add_u32 m0, s32, 0
    s_add_u32 s34, s38, 10240
    buffer_load_dwordx4 v6, s[20:23], s34 offen offset:0 sc1 lds
    buffer_load_dwordx4 v6, s[20:23], s34 offen offset:1024 sc1 lds
    buffer_load_dwordx4 v6, s[20:23], s34 offen offset:2048 sc1 lds
    buffer_load_dwordx4 v6, s[20:23], s34 offen offset:3072 sc1 lds
    s_add_u32 m0, s32, 4096
    s_add_u32 s34, s38, 14336
    buffer_load_dwordx4 v6, s[20:23], s34 offen offset:0 sc1 lds
    buffer_load_dwordx4 v6, s[20:23], s34 offen offset:1024 sc1 lds
    buffer_load_dwordx4 v6, s[20:23], s34 offen offset:2048 sc1 lds
    buffer_load_dwordx4 v6, s[20:23], s34 offen offset:3072 sc1 lds
L_ns:
    s_add_u32 s34, s41, 0
    buffer_load_dwordx4 v[56:59], v6, s[20:23], s34 offen offset:0 sc1
    s_add_u32 s34, s41, 0
    buffer_load_dwordx4 v[60:63], v6, s[20:23], s34 offen offset:1024 sc1
    s_add_u32 s34, s41, 0
    buffer_load_dwordx4 v[64:67], v6, s[20:23], s34 offen offset:2048 sc1
    s_add_u32 s34, s41, 0
    buffer_load_dwordx4 v[68:71], v6, s[20:23], s34 offen offset:3072 sc1
    s_add_u32 s34, s41, 4096
    buffer_load_dwordx4 v[72:75], v6, s[20:23], s34 offen offset:0 sc1
    s_add_u32 s34, s41, 4096
    buffer_load_dwordx4 v[76:79], v6, s[20:23], s34 offen offset:1024 sc1
    s_add_u32 s34, s41, 4096
    buffer_load_dwordx4 v[80:83], v6, s[20:23], s34 offen offset:2048 sc1
    s_add_u32 s34, s41, 4096
    buffer_load_dwordx4 v[84:87], v6, s[20:23], s34 offen offset:3072 sc1
    s_add_u32 s34, s41, 8192
    buffer_load_dwordx4 v[88:91], v6, s[20:23], s34 offen offset:0 sc1
    s_add_u32 s34, s41, 8192
    buffer_load_dwordx4 v[92:95], v6, s[20:23], s34 offen offset:1024 sc1
    s_setprio 0
    s_waitcnt lgkmcnt(0)
    s_barrier
    s_call_b64 s[52:53], L_fa
    s_call_b64 s[52:53], L_ge
    s_barrier
    s_mov_b32 s55, 1
    s_mov_b32 s59, 122880
    s_setprio 0
    s_call_b64 s[52:53], L_hs
    s_waitcnt vmcnt(0)
    s_barrier
    s_branch L_fb
L_Bend:
    s_mul_i32 s50, s31, 3072
    s_add_u32 s50, s50, 110592
    s_xor_b32 s32, s31, 1
    s_mul_i32 s78, s32, 3072
    s_add_u32 s78, s78, 110592
    s_mov_b32 s54, 122880
    s_mov_b32 s55, 0
    s_movk_i32 s59, 1024
    s_call_b64 s[52:53], L_cw
    s_add_u32 s34, s76, 0
    buffer_load_dwordx4 v[156:159], v6, s[20:23], s34 offen offset:0 sc1
    s_add_u32 s34, s76, 0
    buffer_load_dwordx4 v[160:163], v6, s[20:23], s34 offen offset:1024 sc1
    s_add_u32 s34, s76, 0
    buffer_load_dwordx4 v[164:167], v6, s[20:23], s34 offen offset:2048 sc1
    s_add_u32 s34, s76, 0
    buffer_load_dwordx4 v[168:171], v6, s[20:23], s34 offen offset:3072 sc1
    s_add_u32 s34, s76, 4096
    buffer_load_dwordx4 v[172:175], v6, s[20:23], s34 offen offset:0 sc1
    s_add_u32 s34, s76, 4096
    buffer_load_dwordx4 v[176:179], v6, s[20:23], s34 offen offset:1024 sc1
    s_add_u32 s34, s76, 4096
    buffer_load_dwordx4 v[180:183], v6, s[20:23], s34 offen offset:2048 sc1
    s_add_u32 s34, s76, 4096
    buffer_load_dwordx4 v[184:187], v6, s[20:23], s34 offen offset:3072 sc1
    s_add_u32 s34, s76, 8192
    buffer_load_dwordx4 v[188:191], v6, s[20:23], s34 offen offset:0 sc1
    s_waitcnt lgkmcnt(0)
    s_barrier
    s_call_b64 s[52:53], L_cf
    s_cmp_ge_u32 s30, s57
    s_cbranch_scc1 L_bi0
    s_add_u32 s34, s39, 0
    buffer_load_dwordx4 v[96:99], v6, s[20:23], s34 offen offset:0 sc1
    s_add_u32 s34, s39, 0
    buffer_load_dwordx4 v[100:103], v6, s[20:23], s34 offen offset:1024 sc1
    s_add_u32 s34, s39, 0
    buffer_load_dwordx4 v[104:107], v6, s[20:23], s34 offen offset:2048 sc1
    s_add_u32 s34, s39, 0
    buffer_load_dwordx4 v[108:111], v6, s[20:23], s34 offen offset:3072 sc1
    s_add_u32 s34, s39, 4096
    buffer_load_dwordx4 v[112:115], v6, s[20:23], s34 offen offset:0 sc1
    s_add_u32 s34, s39, 4096
    buffer_load_dwordx4 v[116:119], v6, s[20:23], s34 offen offset:1024 sc1
    s_add_u32 s34, s39, 4096
    buffer_load_dwordx4 v[120:123], v6, s[20:23], s34 offen offset:2048 sc1
    s_add_u32 s34, s39, 4096
    buffer_load_dwordx4 v[124:127], v6, s[20:23], s34 offen offset:3072 sc1
    s_add_u32 s34, s39, 8192
    buffer_load_dwordx4 v[128:131], v6, s[20:23], s34 offen offset:0 sc1
    s_add_u32 s34, s39, 8192
    buffer_load_dwordx4 v[132:135], v6, s[20:23], s34 offen offset:1024 sc1
    s_add_u32 s34, s39, 8192
    buffer_load_dwordx4 v[136:139], v6, s[20:23], s34 offen offset:2048 sc1
    s_add_u32 s34, s39, 8192
    buffer_load_dwordx4 v[140:143], v6, s[20:23], s34 offen offset:3072 sc1
    s_add_u32 s34, s39, 12288
    buffer_load_dwordx4 v[144:147], v6, s[20:23], s34 offen offset:0 sc1
    s_add_u32 s34, s39, 12288
    buffer_load_dwordx4 v[148:151], v6, s[20:23], s34 offen offset:1024 sc1
    s_add_u32 s34, s39, 12288
    buffer_load_dwordx4 v[152:155], v6, s[20:23], s34 offen offset:2048 sc1
    s_branch L_bj0
L_bi0:
L_bj0:
    s_call_b64 s[52:53], L_wo
    s_cmp_ge_u32 s30, s57
    s_cbranch_scc1 L_bi1
    s_add_u32 s34, s39, 12288
    buffer_load_dwordx4 v[156:159], v6, s[20:23], s34 offen offset:3072 sc1
    s_add_u32 s34, s39, 16384
    buffer_load_dwordx4 v[160:163], v6, s[20:23], s34 offen offset:0 sc1
    s_add_u32 s34, s39, 16384
    buffer_load_dwordx4 v[164:167], v6, s[20:23], s34 offen offset:1024 sc1
    s_add_u32 s34, s39, 16384
    buffer_load_dwordx4 v[168:171], v6, s[20:23], s34 offen offset:2048 sc1
    s_add_u32 s34, s39, 16384
    buffer_load_dwordx4 v[172:175], v6, s[20:23], s34 offen offset:3072 sc1
    s_add_u32 s34, s39, 20480
    buffer_load_dwordx4 v[176:179], v6, s[20:23], s34 offen offset:0 sc1
    s_add_u32 s34, s39, 20480
    buffer_load_dwordx4 v[180:183], v6, s[20:23], s34 offen offset:1024 sc1
    s_add_u32 s34, s39, 20480
    buffer_load_dwordx4 v[184:187], v6, s[20:23], s34 offen offset:2048 sc1
    s_branch L_bj1
L_bi1:
L_bj1:
    s_waitcnt lgkmcnt(0)
    s_barrier
    s_call_b64 s[52:53], L_rw
    s_cmp_ge_u32 s30, s57
    s_cbranch_scc1 L_idle
    s_setprio 1
    s_add_u32 s34, s39, 20480
    buffer_load_dwordx4 v[188:191], v6, s[20:23], s34 offen offset:3072 sc1
    s_add_u32 s34, s39, 24576
    buffer_load_dwordx4 v[192:195], v6, s[20:23], s34 offen offset:0 sc1
    s_add_u32 s34, s39, 24576
    buffer_load_dwordx4 v[196:199], v6, s[20:23], s34 offen offset:1024 sc1
    s_add_u32 s34, s39, 24576
    buffer_load_dwordx4 v[200:203], v6, s[20:23], s34 offen offset:2048 sc1
    s_add_u32 s34, s39, 24576
    buffer_load_dwordx4 v[204:207], v6, s[20:23], s34 offen offset:3072 sc1
    ds_read_b128 v[28:31], v6 offset:0
    ds_read_b128 v[32:35], v6 offset:1024
    ds_read_b128 v[36:39], v6 offset:2048
    ds_read_b128 v[40:43], v6 offset:3072
    ds_read_b128 v[44:47], v6 offset:4096
    s_waitcnt lgkmcnt(4)
    v_mfma_f32_32x32x16_bf16 v[12:27], v[96:99], v[28:31], 0
    ds_read_b128 v[48:51], v6 offset:5120
    s_waitcnt lgkmcnt(4)
    v_mfma_f32_32x32x16_bf16 v[12:27], v[100:103], v[32:35], v[12:27]
    ds_read_b128 v[28:31], v6 offset:6144
    s_waitcnt lgkmcnt(4)
    v_mfma_f32_32x32x16_bf16 v[12:27], v[104:107], v[36:39], v[12:27]
    ds_read_b128 v[32:35], v6 offset:7168
    s_waitcnt lgkmcnt(4)
    v_mfma_f32_32x32x16_bf16 v[12:27], v[108:111], v[40:43], v[12:27]
    ds_read_b128 v[36:39], v6 offset:8192
    s_waitcnt lgkmcnt(4)
    v_mfma_f32_32x32x16_bf16 v[12:27], v[112:115], v[44:47], v[12:27]
    ds_read_b128 v[40:43], v6 offset:9216
    s_waitcnt lgkmcnt(4)
    v_mfma_f32_32x32x16_bf16 v[12:27], v[116:119], v[48:51], v[12:27]
    ds_read_b128 v[44:47], v6 offset:10240
    s_waitcnt lgkmcnt(4)
    v_mfma_f32_32x32x16_bf16 v[12:27], v[120:123], v[28:31], v[12:27]
    ds_read_b128 v[48:51], v6 offset:11264
    s_waitcnt lgkmcnt(4)
    v_mfma_f32_32x32x16_bf16 v[12:27], v[124:127], v[32:35], v[12:27]
    ds_read_b128 v[28:31], v6 offset:12288
    s_waitcnt lgkmcnt(4)
    v_mfma_f32_32x32x16_bf16 v[12:27], v[128:131], v[36:39], v[12:27]
    ds_read_b128 v[32:35], v6 offset:13312
    s_waitcnt lgkmcnt(4)
    v_mfma_f32_32x32x16_bf16 v[12:27], v[132:135], v[40:43], v[12:27]
    ds_read_b128 v[36:39], v6 offset:14336
    s_waitcnt lgkmcnt(4)
    v_mfma_f32_32x32x16_bf16 v[12:27], v[136:139], v[44:47], v[12:27]
    ds_read_b128 v[40:43], v6 offset:15360
    s_add_u32 s34, s39, 28672
    buffer_load_dwordx4 v[208:211], v6, s[20:23], s34 offen offset:0 sc1
    s_waitcnt lgkmcnt(4)
    v_mfma_f32_32x32x16_bf16 v[12:27], v[140:143], v[48:51], v[12:27]
    ds_read_b128 v[44:47], v6 offset:16384
    s_add_u32 s34, s39, 28672
    buffer_load_dwordx4 v[212:215], v6, s[20:23], s34 offen offset:1024 sc1
    s_waitcnt lgkmcnt(4)
    v_mfma_f32_32x32x16_bf16 v[12:27], v[144:147], v[28:31], v[12:27]
    ds_read_b128 v[48:51], v6 offset:17408
    s_add_u32 s34, s39, 28672
    buffer_load_dwordx4 v[216:219], v6, s[20:23], s34 offen offset:2048 sc1
    s_waitcnt lgkmcnt(4)
    v_mfma_f32_32x32x16_bf16 v[12:27], v[148:151], v[32:35], v[12:27]
    ds_read_b128 v[28:31], v6 offset:18432
    s_add_u32 s34, s39, 28672
    buffer_load_dwordx4 v[220:223], v6, s[20:23], s34 offen offset:3072 sc1
    s_waitcnt lgkmcnt(4)
    v_mfma_f32_32x32x16_bf16 v[12:27], v[152:155], v[36:39], v[12:27]
    ds_read_b128 v[32:35], v6 offset:19456
    s_add_u32 s34, s39, 32768
    buffer_load_dwordx4 v[224:227], v6, s[20:23], s34 offen offset:0 sc1
    s_waitcnt lgkmcnt(4)
    v_mfma_f32_32x32x16_bf16 v[12:27], v[156:159], v[40:43], v[12:27]
    ds_read_b128 v[36:39], v6 offset:20480
    s_add_u32 s34, s39, 32768
    buffer_load_dwordx4 v[228:231], v6, s[20:23], s34 offen offset:1024 sc1
    s_waitcnt lgkmcnt(4)
    v_mfma_f32_32x32x16_bf16 v[12:27], v[160:163], v[44:47], v[12:27]
    ds_read_b128 v[40:43], v6 offset:21504
    s_add_u32 s34, s39, 32768
    buffer_load_dwordx4 v[232:235], v6, s[20:23], s34 offen offset:2048 sc1
    s_waitcnt lgkmcnt(4)
    v_mfma_f32_32x32x16_bf16 v[12:27], v[164:167], v[48:51], v[12:27]
    ds_read_b128 v[44:47], v6 offset:22528
    s_add_u32 s34, s39, 32768
    buffer_load_dwordx4 v[236:239], v6, s[20:23], s34 offen offset:3072 sc1
    s_waitcnt lgkmcnt(4)
    v_mfma_f32_32x32x16_bf16 v[12:27], v[168:171], v[28:31], v[12:27]
    ds_read_b128 v[48:51], v6 offset:23552
    s_add_u32 s34, s39, 36864
    buffer_load_dwordx4 v[240:243], v6, s[20:23], s34 offen offset:0 sc1
    s_waitcnt lgkmcnt(4)
    v_mfma_f32_32x32x16_bf16 v[12:27], v[172:175], v[32:35], v[12:27]
    ds_read_b128 v[28:31], v6 offset:24576
    s_add_u32 s34, s39, 36864
    buffer_load_dwordx4 v[244:247], v6, s[20:23], s34 offen offset:1024 sc1
    s_waitcnt lgkmcnt(4)
    v_mfma_f32_32x32x16_bf16 v[12:27], v[176:179], v[36:39], v[12:27]
    ds_read_b128 v[32:35], v6 offset:25600
    s_add_u32 s34, s39, 36864
    buffer_load_dwordx4 v[248:251], v6, s[20:23], s34 offen offset:2048 sc1
    s_waitcnt lgkmcnt(4)
    v_mfma_f32_32x32x16_bf16 v[12:27], v[180:183], v[40:43], v[12:27]
    ds_read_b128 v[36:39], v6 offset:26624
    s_add_u32 s34, s39, 36864
    buffer_load_dwordx4 v[252:255], v6, s[20:23], s34 offen offset:3072 sc1
    s_waitcnt lgkmcnt(4)
    v_mfma_f32_32x32x16_bf16 v[12:27], v[184:187], v[44:47], v[12:27]
    ds_read_b128 v[40:43], v6 offset:27648
    s_add_u32 s34, s41, 0
    buffer_load_dwordx4 v[56:59], v6, s[20:23], s34 offen offset:0 sc1
    s_waitcnt vmcnt(17) lgkmcnt(4)
    v_mfma_f32_32x32x16_bf16 v[12:27], v[188:191], v[48:51], v[12:27]
    ds_read_b128 v[44:47], v6 offset:28672
    s_add_u32 s34, s41, 0
    buffer_load_dwordx4 v[60:63], v6, s[20:23], s34 offen offset:1024 sc1
    s_waitcnt vmcnt(17) lgkmcnt(4)
    v_mfma_f32_32x32x16_bf16 v[12:27], v[192:195], v[28:31], v[12:27]
    ds_read_b128 v[48:51], v6 offset:29696
    s_add_u32 s34, s41, 0
    buffer_load_dwordx4 v[64:67], v6, s[20:23], s34 offen offset:2048 sc1
    s_waitcnt vmcnt(17) lgkmcnt(4)
    v_mfma_f32_32x32x16_bf16 v[12:27], v[196:199], v[32:35], v[12:27]
    ds_read_b128 v[28:31], v6 offset:30720
    s_add_u32 s34, s41, 0
    buffer_load_dwordx4 v[68:71], v6, s[20:23], s34 offen offset:3072 sc1
    s_waitcnt vmcnt(17) lgkmcnt(4)
    v_mfma_f32_32x32x16_bf16 v[12:27], v[200:203], v[36:39], v[12:27]
    ds_read_b128 v[32:35], v6 offset:31744
    s_add_u32 s34, s41, 4096
    buffer_load_dwordx4 v[72:75], v6, s[20:23], s34 offen offset:0 sc1
    s_waitcnt vmcnt(17) lgkmcnt(4)
    v_mfma_f32_32x32x16_bf16 v[12:27], v[204:207], v[40:43], v[12:27]
    ds_read_b128 v[36:39], v6 offset:32768
    s_add_u32 s34, s41, 4096
    buffer_load_dwordx4 v[76:79], v6, s[20:23], s34 offen offset:1024 sc1
    s_waitcnt vmcnt(17) lgkmcnt(4)
    v_mfma_f32_32x32x16_bf16 v[12:27], v[208:211], v[44:47], v[12:27]
    ds_read_b128 v[40:43], v6 offset:33792
    s_add_u32 s34, s41, 4096
    buffer_load_dwordx4 v[80:83], v6, s[20:23], s34 offen offset:2048 sc1
    s_waitcnt vmcnt(17) lgkmcnt(4)
    v_mfma_f32_32x32x16_bf16 v[12:27], v[212:215], v[48:51], v[12:27]
    ds_read_b128 v[44:47], v6 offset:34816
    s_add_u32 s34, s41, 4096
    buffer_load_dwordx4 v[84:87], v6, s[20:23], s34 offen offset:3072 sc1
    s_waitcnt vmcnt(17) lgkmcnt(4)
    v_mfma_f32_32x32x16_bf16 v[12:27], v[216:219], v[28:31], v[12:27]
    ds_read_b128 v[48:51], v6 offset:35840
    s_add_u32 s34, s41, 8192
    buffer_load_dwordx4 v[88:91], v6, s[20:23], s34 offen offset:0 sc1
    s_waitcnt vmcnt(17) lgkmcnt(4)
    v_mfma_f32_32x32x16_bf16 v[12:27], v[220:223], v[32:35], v[12:27]
    ds_read_b128 v[28:31], v6 offset:36864
    s_add_u32 s34, s41, 8192
    buffer_load_dwordx4 v[92:95], v6, s[20:23], s34 offen offset:1024 sc1
    s_waitcnt vmcnt(17) lgkmcnt(4)
    v_mfma_f32_32x32x16_bf16 v[12:27], v[224:227], v[36:39], v[12:27]
    ds_read_b128 v[32:35], v6 offset:37888
    s_waitcnt vmcnt(16) lgkmcnt(4)
    v_mfma_f32_32x32x16_bf16 v[12:27], v[228:231], v[40:43], v[12:27]
    ds_read_b128 v[36:39], v6 offset:38912
    s_waitcnt vmcnt(15) lgkmcnt(4)
    v_mfma_f32_32x32x16_bf16 v[12:27], v[232:235], v[44:47], v[12:27]
    ds_read_b128 v[40:43], v6 offset:39936
    s_waitcnt vmcnt(14) lgkmcnt(4)
    v_mfma_f32_32x32x16_bf16 v[12:27], v[236:239], v[48:51], v[12:27]
    s_waitcnt vmcnt(13) lgkmcnt(3)
    v_mfma_f32_32x32x16_bf16 v[12:27], v[240:243], v[28:31], v[12:27]
    s_waitcnt vmcnt(12) lgkmcnt(2)
    v_mfma_f32_32x32x16_bf16 v[12:27], v[244:247], v[32:35], v[12:27]
    s_waitcnt vmcnt(11) lgkmcnt(1)
    v_mfma_f32_32x32x16_bf16 v[12:27], v[248:251], v[36:39], v[12:27]
    s_waitcnt vmcnt(10) lgkmcnt(0)
    v_mfma_f32_32x32x16_bf16 v[12:27], v[252:255], v[40:43], v[12:27]
    s_mov_b32 s101, 1
    s_call_b64 s[52:53], L_ge
    s_mov_b32 s55, 1
    s_mov_b32 s101, 0
L_fb:
    s_setprio 2
    v_add_u32 v3, 122880, v6
    s_lshr_b32 s32, s30, 2
    s_add_u32 s32, s32, 1
    s_mul_i32 s32, s32, 40960
    s_mul_i32 s33, s31, 8192
    s_add_u32 s32, s32, s33
    v_add_u32 v2, s32, v6
    ds_read_b128 v[28:31], v3 offset:0
    ds_read_b128 v[32:35], v3 offset:1024
    ds_read_b128 v[36:39], v3 offset:2048
    ds_read_b128 v[40:43], v3 offset:3072
    ds_read_b128 v[44:47], v3 offset:4096
    s_waitcnt lgkmcnt(4)
    v_mfma_f32_32x32x16_bf16 v[12:27], v[96:99], v[28:31], 0
    ds_read_b128 v[48:51], v3 offset:5120
    ds_read_b128 v[96:99], v2 offset:0
    s_waitcnt lgkmcnt(5)
    v_mfma_f32_32x32x16_bf16 v[12:27], v[100:103], v[32:35], v[12:27]
    ds_read_b128 v[28:31], v3 offset:6144
    ds_read_b128 v[100:103], v2 offset:1024
    s_waitcnt lgkmcnt(6)
    v_mfma_f32_32x32x16_bf16 v[12:27], v[104:107], v[36:39], v[12:27]
    ds_read_b128 v[32:35], v3 offset:7168
    ds_read_b128 v[104:107], v2 offset:2048
    s_waitcnt lgkmcnt(7)
    v_mfma_f32_32x32x16_bf16 v[12:27], v[108:111], v[40:43], v[12:27]
    ds_read_b128 v[36:39], v3 offset:8192
    ds_read_b128 v[108:111], v2 offset:3072
    s_waitcnt lgkmcnt(8)
    v_mfma_f32_32x32x16_bf16 v[12:27], v[112:115], v[44:47], v[12:27]
    ds_read_b128 v[40:43], v3 offset:9216
    ds_read_b128 v[112:115], v2 offset:4096
    s_waitcnt lgkmcnt(9)
    v_mfma_f32_32x32x16_bf16 v[12:27], v[116:119], v[48:51], v[12:27]
    ds_read_b128 v[44:47], v3 offset:10240
    ds_read_b128 v[116:119], v2 offset:5120
    s_waitcnt lgkmcnt(9)
    v_mfma_f32_32x32x16_bf16 v[12:27], v[120:123], v[28:31], v[12:27]
    ds_read_b128 v[48:51], v3 offset:11264
    ds_read_b128 v[120:123], v2 offset:6144
    s_waitcnt lgkmcnt(9)
    v_mfma_f32_32x32x16_bf16 v[12:27], v[124:127], v[32:35], v[12:27]
    ds_read_b128 v[28:31], v3 offset:12288
    ds_read_b128 v[124:127], v2 offset:7168
    s_waitcnt lgkmcnt(9)
    v_mfma_f32_32x32x16_bf16 v[12:27], v[128:131], v[36:39], v[12:27]
    ds_read_b128 v[32:35], v3 offset:13312
    s_add_u32 s34, s41, 16384
    buffer_load_dwordx4 v[128:131], v6, s[20:23], s34 offen offset:2048 sc1
    s_waitcnt lgkmcnt(8)
    v_mfma_f32_32x32x16_bf16 v[12:27], v[132:135], v[40:43], v[12:27]
    ds_read_b128 v[36:39], v3 offset:14336
    s_waitcnt lgkmcnt(7)
    v_mfma_f32_32x32x16_bf16 v[12:27], v[136:139], v[44:47], v[12:27]
    ds_read_b128 v[40:43], v3 offset:15360
    s_add_u32 s34, s41, 16384
    buffer_load_dwordx4 v[132:135], v6, s[20:23], s34 offen offset:3072 sc1
    s_waitcnt lgkmcnt(6)
    v_mfma_f32_32x32x16_bf16 v[12:27], v[140:143], v[48:51], v[12:27]
    ds_read_b128 v[44:47], v3 offset:16384
    s_waitcnt lgkmcnt(5)
    v_mfma_f32_32x32x16_bf16 v[12:27], v[144:147], v[28:31], v[12:27]
    ds_read_b128 v[48:51], v3 offset:17408
    s_lshl_b32 s32, s30, 8
    s_add_u32 s32, s32, 106496
    v_lshrrev_b32 v2, 5, v1
    v_lshl_add_u32 v10, v2, 4, s32
    s_add_u32 s34, s41, 20480
    buffer_load_dwordx4 v[136:139], v6, s[20:23], s34 offen offset:0 sc1
    s_waitcnt lgkmcnt(4)
    v_mfma_f32_32x32x16_bf16 v[12:27], v[148:151], v[32:35], v[12:27]
    ds_read_b128 v[28:31], v3 offset:18432
    v_and_b32 v11, 15, v1
    v_lshlrev_b32 v11, 4, v11
    v_lshl_add_u32 v11, v2, 8, v11
    s_waitcnt lgkmcnt(4)
    v_mfma_f32_32x32x16_bf16 v[12:27], v[152:155], v[36:39], v[12:27]
    ds_read_b128 v[32:35], v3 offset:19456
    s_add_u32 s34, s41, 20480
    buffer_load_dwordx4 v[140:143], v6, s[20:23], s34 offen offset:1024 sc1
    s_waitcnt lgkmcnt(4)
    v_mfma_f32_32x32x16_bf16 v[12:27], v[156:159], v[40:43], v[12:27]
    ds_read_b128 v[36:39], v3 offset:20480
    v_bfe_u32 v2, v1, 4, 1
    v_mul_u32_u24 v2, 55296, v2
    v_add_u32 v11, v11, v2
    s_waitcnt lgkmcnt(4)
    v_mfma_f32_32x32x16_bf16 v[12:27], v[160:163], v[44:47], v[12:27]
    ds_read_b128 v[40:43], v3 offset:21504
    s_add_u32 s34, s41, 20480
    buffer_load_dwordx4 v[144:147], v6, s[20:23], s34 offen offset:2048 sc1
    s_waitcnt lgkmcnt(4)
    v_mfma_f32_32x32x16_bf16 v[12:27], v[164:167], v[48:51], v[12:27]
    ds_read_b128 v[44:47], v3 offset:22528
    v_and_b32 v2, 31, v1
    v_lshlrev_b32 v2, 3, v2
    v_add_u32 v2, 108800, v2
    v_add_u32 v0, 4096, v6
    s_waitcnt lgkmcnt(4)
    v_mfma_f32_32x32x16_bf16 v[12:27], v[168:171], v[28:31], v[12:27]
    ds_read_b128 v[48:51], v3 offset:23552
    s_add_u32 s34, s41, 20480
    buffer_load_dwordx4 v[148:151], v6, s[20:23], s34 offen offset:3072 sc1
    s_waitcnt lgkmcnt(4)
    v_mfma_f32_32x32x16_bf16 v[12:27], v[172:175], v[32:35], v[12:27]
    ds_read_b128 v[28:31], v3 offset:24576
    ds_read_b64 v[4:5], v2
    v_mov_b32 v2, 109056
    s_waitcnt lgkmcnt(5)
    v_mfma_f32_32x32x16_bf16 v[12:27], v[176:179], v[36:39], v[12:27]
    ds_read_b128 v[32:35], v3 offset:25600
    s_add_u32 s34, s41, 24576
    buffer_load_dwordx4 v[152:155], v6, s[20:23], s34 offen offset:0 sc1
    s_waitcnt lgkmcnt(5)
    v_mfma_f32_32x32x16_bf16 v[12:27], v[180:183], v[40:43], v[12:27]
    ds_read_b128 v[36:39], v3 offset:26624
    s_add_u32 s4, s63, 32
    s_mul_i32 s4, s4, 108
    s_add_u32 s4, s4, s58
    s_lshl_b32 s4, s4, 10
    s_waitcnt lgkmcnt(5)
    v_mfma_f32_32x32x16_bf16 v[12:27], v[184:187], v[44:47], v[12:27]
    ds_read_b128 v[40:43], v3 offset:27648
    s_add_u32 s34, s41, 24576
    buffer_load_dwordx4 v[156:159], v6, s[20:23], s34 offen offset:1024 sc1
    s_waitcnt lgkmcnt(5)
    v_mfma_f32_32x32x16_bf16 v[12:27], v[188:191], v[48:51], v[12:27]
    ds_read_b128 v[44:47], v3 offset:28672
    s_add_u32 s4, s4, 25165824
    s_mov_b32 s5, 0xbdd2d3e8
    s_add_u32 s6, s61, 768
    s_waitcnt lgkmcnt(5)
    v_mfma_f32_32x32x16_bf16 v[12:27], v[192:195], v[28:31], v[12:27]
    ds_read_b128 v[48:51], v3 offset:29696
    s_add_u32 s34, s41, 24576
    buffer_load_dwordx4 v[160:163], v6, s[20:23], s34 offen offset:2048 sc1
    s_waitcnt lgkmcnt(4)
    v_mfma_f32_32x32x16_bf16 v[12:27], v[196:199], v[32:35], v[12:27]
    ds_read_b128 v[28:31], v3 offset:30720
    s_lshl_b32 s32, s63, 1
    s_mul_i32 s64, s32, 55296
    s_lshl_b32 s33, s68, 10
    s_add_u32 s64, s64, s33
    s_waitcnt lgkmcnt(4)
    v_mfma_f32_32x32x16_bf16 v[12:27], v[200:203], v[36:39], v[12:27]
    ds_read_b128 v[32:35], v3 offset:31744
    s_add_u32 s34, s41, 24576
    buffer_load_dwordx4 v[164:167], v6, s[20:23], s34 offen offset:3072 sc1
    s_waitcnt lgkmcnt(4)
    v_mfma_f32_32x32x16_bf16 v[12:27], v[204:207], v[40:43], v[12:27]
    ds_read_b128 v[36:39], v3 offset:32768
    s_add_u32 s64, s64, 25165824
    s_add_u32 s65, s64, 55296
    s_add_u32 s66, s64, 3538944
    s_add_u32 s67, s66, 55296
    s_waitcnt lgkmcnt(4)
    v_mfma_f32_32x32x16_bf16 v[12:27], v[208:211], v[44:47], v[12:27]
    ds_read_b128 v[40:43], v3 offset:33792
    s_add_u32 s34, s41, 28672
    buffer_load_dwordx4 v[168:171], v6, s[20:23], s34 offen offset:0 sc1
    s_waitcnt lgkmcnt(4)
    v_mfma_f32_32x32x16_bf16 v[12:27], v[212:215], v[48:51], v[12:27]
    ds_read_b128 v[44:47], v3 offset:34816
    s_waitcnt lgkmcnt(4)
    v_mfma_f32_32x32x16_bf16 v[12:27], v[216:219], v[28:31], v[12:27]
    ds_read_b128 v[48:51], v3 offset:35840
    s_add_u32 s34, s41, 28672
    buffer_load_dwordx4 v[172:175], v6, s[20:23], s34 offen offset:1024 sc1
    s_waitcnt lgkmcnt(4)
    v_mfma_f32_32x32x16_bf16 v[12:27], v[220:223], v[32:35], v[12:27]
    ds_read_b128 v[28:31], v3 offset:36864
    s_waitcnt lgkmcnt(4)
    v_mfma_f32_32x32x16_bf16 v[12:27], v[224:227], v[36:39], v[12:27]
    ds_read_b128 v[32:35], v3 offset:37888
    s_add_u32 s34, s41, 28672
    buffer_load_dwordx4 v[176:179], v6, s[20:23], s34 offen offset:2048 sc1
    s_waitcnt lgkmcnt(4)
    v_mfma_f32_32x32x16_bf16 v[12:27], v[228:231], v[40:43], v[12:27]
    ds_read_b128 v[36:39], v3 offset:38912
    s_waitcnt lgkmcnt(4)
    v_mfma_f32_32x32x16_bf16 v[12:27], v[232:235], v[44:47], v[12:27]
    ds_read_b128 v[40:43], v3 offset:39936
    s_add_u32 s34, s41, 28672
    buffer_load_dwordx4 v[180:183], v6, s[20:23], s34 offen offset:3072 sc1
    s_waitcnt lgkmcnt(4)
    v_mfma_f32_32x32x16_bf16 v[12:27], v[236:239], v[48:51], v[12:27]
    ds_read_b128 v[44:47], v10
    ds_read_b128 v[48:51], v10 offset:32
    s_waitcnt lgkmcnt(5)
    v_mfma_f32_32x32x16_bf16 v[12:27], v[240:243], v[28:31], v[12:27]
    ds_read_b128 v[28:31], v10 offset:128
    ds_read_b32 v2, v2
    s_add_u32 s34, s41, 32768
    buffer_load_dwordx4 v[184:187], v6, s[20:23], s34 offen offset:0 sc1
    s_waitcnt lgkmcnt(6)
    v_mfma_f32_32x32x16_bf16 v[12:27], v[244:247], v[32:35], v[12:27]
    ds_read_b128 v[32:35], v10 offset:160
    s_waitcnt lgkmcnt(6)
    v_mfma_f32_32x32x16_bf16 v[12:27], v[248:251], v[36:39], v[12:27]
    s_add_u32 s34, s41, 32768
    buffer_load_dwordx4 v[188:191], v6, s[20:23], s34 offen offset:1024 sc1
    s_waitcnt lgkmcnt(5)
    v_mfma_f32_32x32x16_bf16 v[12:27], v[252:255], v[40:43], v[12:27]
    s_add_u32 s34, s41, 32768
    buffer_load_dwordx4 v[192:195], v6, s[20:23], s34 offen offset:2048 sc1
    s_setprio 0
    v_mov_b32 v3, 0xc0135761
    s_waitcnt lgkmcnt(0)
    v_cmp_ne_u32 vcc, 0, v2
    s_cbranch_vccnz L_lpx
    s_mov_b32 s42, 0
L_lp:
    v_mov_b32 v2, 109056
    ds_read_b32 v2, v2
    s_add_u32 s42, s42, 1
    s_cmp_gt_u32 s42, 0x400000
    s_cbranch_scc1 L_lpx
    s_waitcnt lgkmcnt(0)
    v_cmp_ne_u32 vcc, 0, v2
    s_cbranch_vccz L_lp
L_lpx:
    buffer_load_dwordx4 v[196:199], v6, s[20:23], s64 offen offset:0 sc1
    buffer_load_dwordx4 v[200:203], v6, s[20:23], s64 offen offset:1024 sc1
    buffer_load_dwordx4 v[204:207], v6, s[20:23], s64 offen offset:2048 sc1
    s_nop 4
    v_fmac_f32 v12, v4, v44
    v_fmac_f32 v13, v4, v45
    v_fmac_f32 v14, v4, v46
    v_fmac_f32 v15, v4, v47
    v_fmac_f32 v16, v4, v48
    v_fmac_f32 v17, v4, v49
    v_fmac_f32 v18, v4, v50
    v_fmac_f32 v19, v4, v51
    v_fma_f32 v12, v12, v5, v28
    v_fma_f32 v13, v13, v5, v29
    v_fma_f32 v14, v14, v5, v30
    v_fma_f32 v15, v15, v5, v31
    v_fma_f32 v16, v16, v5, v32
    v_fma_f32 v17, v17, v5, v33
    v_fma_f32 v18, v18, v5, v34
    v_fma_f32 v19, v19, v5, v35
    ds_read_b128 v[44:47], v10 offset:64
    ds_read_b128 v[28:31], v10 offset:192
    ds_read_b128 v[48:51], v10 offset:96
    ds_read_b128 v[32:35], v10 offset:224
    v_mul_f32 v36, v12, v12
    v_mul_f32 v37, v13, v13
    v_mul_f32 v38, v14, v14
    v_mul_f32 v39, v15, v15
    v_mul_f32 v40, v16, v16
    v_mul_f32 v41, v17, v17
    v_mul_f32 v42, v18, v18
    v_mul_f32 v43, v19, v19
    v_fma_f32 v36, v36, s5, v3
    v_fma_f32 v37, v37, s5, v3
    v_fma_f32 v38, v38, s5, v3
    v_fma_f32 v39, v39, s5, v3
    v_fma_f32 v40, v40, s5, v3
    v_fma_f32 v41, v41, s5, v3
    v_fma_f32 v42, v42, s5, v3
    v_fma_f32 v43, v43, s5, v3
    v_mul_f32 v36, v36, v12
    v_mul_f32 v37, v37, v13
    v_mul_f32 v38, v38, v14
    v_mul_f32 v39, v39, v15
    v_mul_f32 v40, v40, v16
    v_mul_f32 v41, v41, v17
    v_mul_f32 v42, v42, v18
    v_mul_f32 v43, v43, v19
    v_exp_f32 v36, v36
    v_exp_f32 v37, v37
    v_exp_f32 v38, v38
    v_exp_f32 v39, v39
    v_exp_f32 v40, v40
    v_exp_f32 v41, v41
    v_exp_f32 v42, v42
    v_exp_f32 v43, v43
    v_add_f32 v36, 1.0, v36
    v_add_f32 v37, 1.0, v37
    v_add_f32 v38, 1.0, v38
    v_add_f32 v39, 1.0, v39
    v_add_f32 v40, 1.0, v40
    v_add_f32 v41, 1.0, v41
    v_add_f32 v42, 1.0, v42
    v_add_f32 v43, 1.0, v43
    v_rcp_f32 v36, v36
    v_rcp_f32 v37, v37
    v_rcp_f32 v38, v38
    v_rcp_f32 v39, v39
    v_rcp_f32 v40, v40
    v_rcp_f32 v41, v41
    v_rcp_f32 v42, v42
    v_rcp_f32 v43, v43
    v_mul_f32 v12, v12, v36
    v_mul_f32 v13, v13, v37
    v_mul_f32 v14, v14, v38
    v_mul_f32 v15, v15, v39
    v_mul_f32 v16, v16, v40
    v_mul_f32 v17, v17, v41
    v_mul_f32 v18, v18, v42
    v_mul_f32 v19, v19, v43
    v_cvt_pk_bf16_f32 v12, v12, v13
    v_cvt_pk_bf16_f32 v13, v14, v15
    v_cvt_pk_bf16_f32 v14, v16, v17
    v_cvt_pk_bf16_f32 v15, v18, v19
    buffer_store_dwordx4 v[12:15], v11, s[20:23], s4 offen offset:0 sc1
    buffer_load_dwordx4 v[208:211], v6, s[20:23], s64 offen offset:3072 sc1
    buffer_load_dwordx4 v[212:215], v0, s[20:23], s64 offen offset:0 sc1
    buffer_load_dwordx4 v[216:219], v0, s[20:23], s64 offen offset:1024 sc1
    buffer_load_dwordx4 v[220:223], v0, s[20:23], s64 offen offset:2048 sc1
    s_waitcnt lgkmcnt(0)
    v_fmac_f32 v20, v4, v44
    v_fmac_f32 v21, v4, v45
    v_fmac_f32 v22, v4, v46
    v_fmac_f32 v23, v4, v47
    v_fmac_f32 v24, v4, v48
    v_fmac_f32 v25, v4, v49
    v_fmac_f32 v26, v4, v50
    v_fmac_f32 v27, v4, v51
    v_fma_f32 v20, v20, v5, v28
    v_fma_f32 v21, v21, v5, v29
    v_fma_f32 v22, v22, v5, v30
    v_fma_f32 v23, v23, v5, v31
    v_fma_f32 v24, v24, v5, v32
    v_fma_f32 v25, v25, v5, v33
    v_fma_f32 v26, v26, v5, v34
    v_fma_f32 v27, v27, v5, v35
    v_mul_f32 v36, v20, v20
    v_mul_f32 v37, v21, v21
    v_mul_f32 v38, v22, v22
    v_mul_f32 v39, v23, v23
    v_mul_f32 v40, v24, v24
    v_mul_f32 v41, v25, v25
    v_mul_f32 v42, v26, v26
    v_mul_f32 v43, v27, v27
    v_fma_f32 v36, v36, s5, v3
    v_fma_f32 v37, v37, s5, v3
    v_fma_f32 v38, v38, s5, v3
    v_fma_f32 v39, v39, s5, v3
    v_fma_f32 v40, v40, s5, v3
    v_fma_f32 v41, v41, s5, v3
    v_fma_f32 v42, v42, s5, v3
    v_fma_f32 v43, v43, s5, v3
    v_mul_f32 v36, v36, v20
    v_mul_f32 v37, v37, v21
    v_mul_f32 v38, v38, v22
    v_mul_f32 v39, v39, v23
    v_mul_f32 v40, v40, v24
    v_mul_f32 v41, v41, v25
    v_mul_f32 v42, v42, v26
    v_mul_f32 v43, v43, v27
    v_exp_f32 v36, v36
    v_exp_f32 v37, v37
    v_exp_f32 v38, v38
    v_exp_f32 v39, v39
    v_exp_f32 v40, v40
    v_exp_f32 v41, v41
    v_exp_f32 v42, v42
    v_exp_f32 v43, v43
    v_add_f32 v36, 1.0, v36
    v_add_f32 v37, 1.0, v37
    v_add_f32 v38, 1.0, v38
    v_add_f32 v39, 1.0, v39
    v_add_f32 v40, 1.0, v40
    v_add_f32 v41, 1.0, v41
    v_add_f32 v42, 1.0, v42
    v_add_f32 v43, 1.0, v43
    v_rcp_f32 v36, v36
    v_rcp_f32 v37, v37
    v_rcp_f32 v38, v38
    v_rcp_f32 v39, v39
    v_rcp_f32 v40, v40
    v_rcp_f32 v41, v41
    v_rcp_f32 v42, v42
    v_rcp_f32 v43, v43
    v_mul_f32 v20, v20, v36
    v_mul_f32 v21, v21, v37
    v_mul_f32 v22, v22, v38
    v_mul_f32 v23, v23, v39
    v_mul_f32 v24, v24, v40
    v_mul_f32 v25, v25, v41
    v_mul_f32 v26, v26, v42
    v_mul_f32 v27, v27, v43
    v_cvt_pk_bf16_f32 v20, v20, v21
    v_cvt_pk_bf16_f32 v21, v22, v23
    v_cvt_pk_bf16_f32 v22, v24, v25
    v_cvt_pk_bf16_f32 v23, v26, v27
    buffer_store_dwordx4 v[20:23], v11, s[20:23], s4 offen offset:512 sc1
    s_branch L_f2
L_idle:
    s_add_u32 s32, s61, 512
    v_mov_b32 v4, 0
    v_mov_b32 v5, s36
    s_mov_b64 exec, 1
    s_waitcnt vmcnt(0)
    s_cmp_eq_u32 s72, 0
    s_cbranch_scc1 L_lspi
    buffer_store_dword v5, v4, s[20:23], s32 offen
L_lepi:
    s_mov_b64 exec, -1
    s_add_u32 s6, s61, 768
    s_mov_b32 s55, 1
    s_cmp_lg_u32 s30, 7
    s_cbranch_scc1 L_i6
    s_add_u32 s62, s51, 384
    v_lshlrev_b32 v4, 2, v1
    s_mov_b32 s42, 0
    s_mov_b64 exec, 4294967295
L_gi:
    buffer_load_dword v5, v4, s[20:23], s62 offen sc1
    s_add_u32 s42, s42, 1
    s_cmp_gt_u32 s42, 0x100000
    s_cbranch_scc1 L_gix
    s_waitcnt vmcnt(0)
    v_cmp_eq_u32 vcc, s36, v5
    s_cmp_eq_u64 vcc, exec
    s_cbranch_scc0 L_gi
L_gix:
    s_mov_b64 exec, -1
    s_call_b64 s[52:53], L_st
    s_branch L_i7
L_i6:
L_i7:
    s_waitcnt lgkmcnt(0)
    s_barrier
    s_add_u32 s34, s41, 0
    buffer_load_dwordx4 v[56:59], v6, s[20:23], s34 offen offset:0 sc1
    s_add_u32 s34, s41, 0
    buffer_load_dwordx4 v[60:63], v6, s[20:23], s34 offen offset:1024 sc1
    s_add_u32 s34, s41, 0
    buffer_load_dwordx4 v[64:67], v6, s[20:23], s34 offen offset:2048 sc1
    s_add_u32 s34, s41, 0
    buffer_load_dwordx4 v[68:71], v6, s[20:23], s34 offen offset:3072 sc1
    s_add_u32 s34, s41, 4096
    buffer_load_dwordx4 v[72:75], v6, s[20:23], s34 offen offset:0 sc1
    s_add_u32 s34, s41, 4096
    buffer_load_dwordx4 v[76:79], v6, s[20:23], s34 offen offset:1024 sc1
    s_add_u32 s34, s41, 4096
    buffer_load_dwordx4 v[80:83], v6, s[20:23], s34 offen offset:2048 sc1
    s_add_u32 s34, s41, 4096
    buffer_load_dwordx4 v[84:87], v6, s[20:23], s34 offen offset:3072 sc1
    s_add_u32 s34, s41, 8192
    buffer_load_dwordx4 v[88:91], v6, s[20:23], s34 offen offset:0 sc1
    s_add_u32 s34, s41, 8192
    buffer_load_dwordx4 v[92:95], v6, s[20:23], s34 offen offset:1024 sc1
    s_add_u32 s34, s41, 8192
    buffer_load_dwordx4 v[96:99], v6, s[20:23], s34 offen offset:2048 sc1
    s_add_u32 s34, s41, 8192
    buffer_load_dwordx4 v[100:103], v6, s[20:23], s34 offen offset:3072 sc1
    s_add_u32 s34, s41, 12288
    buffer_load_dwordx4 v[104:107], v6, s[20:23], s34 offen offset:0 sc1
    s_add_u32 s34, s41, 12288
    buffer_load_dwordx4 v[108:111], v6, s[20:23], s34 offen offset:1024 sc1
    s_add_u32 s34, s41, 12288
    buffer_load_dwordx4 v[112:115], v6, s[20:23], s34 offen offset:2048 sc1
    s_add_u32 s34, s41, 12288
    buffer_load_dwordx4 v[116:119], v6, s[20:23], s34 offen offset:3072 sc1
    s_add_u32 s34, s41, 16384
    buffer_load_dwordx4 v[120:123], v6, s[20:23], s34 offen offset:0 sc1
    s_add_u32 s34, s41, 16384
    buffer_load_dwordx4 v[124:127], v6, s[20:23], s34 offen offset:1024 sc1
    s_add_u32 s34, s41, 16384
    buffer_load_dwordx4 v[128:131], v6, s[20:23], s34 offen offset:2048 sc1
    s_add_u32 s34, s41, 16384
    buffer_load_dwordx4 v[132:135], v6, s[20:23], s34 offen offset:3072 sc1
    s_add_u32 s34, s41, 20480
    buffer_load_dwordx4 v[136:139], v6, s[20:23], s34 offen offset:0 sc1
    s_add_u32 s34, s41, 20480
    buffer_load_dwordx4 v[140:143], v6, s[20:23], s34 offen offset:1024 sc1
    s_add_u32 s34, s41, 20480
    buffer_load_dwordx4 v[144:147], v6, s[20:23], s34 offen offset:2048 sc1
    s_add_u32 s34, s41, 20480
    buffer_load_dwordx4 v[148:151], v6, s[20:23], s34 offen offset:3072 sc1
    s_add_u32 s34, s41, 24576
    buffer_load_dwordx4 v[152:155], v6, s[20:23], s34 offen offset:0 sc1
    s_add_u32 s34, s41, 24576
    buffer_load_dwordx4 v[156:159], v6, s[20:23], s34 offen offset:1024 sc1
    s_add_u32 s34, s41, 24576
    buffer_load_dwordx4 v[160:163], v6, s[20:23], s34 offen offset:2048 sc1
    s_add_u32 s34, s41, 24576
    buffer_load_dwordx4 v[164:167], v6, s[20:23], s34 offen offset:3072 sc1
    s_add_u32 s34, s41, 28672
    buffer_load_dwordx4 v[168:171], v6, s[20:23], s34 offen offset:0 sc1
    s_add_u32 s34, s41, 28672
    buffer_load_dwordx4 v[172:175], v6, s[20:23], s34 offen offset:1024 sc1
    s_lshl_b32 s32, s63, 1
    s_mul_i32 s64, s32, 55296
    s_lshl_b32 s33, s68, 10
    s_add_u32 s64, s64, s33
    s_add_u32 s64, s64, 25165824
    s_add_u32 s65, s64, 55296
    s_add_u32 s66, s64, 3538944
    s_add_u32 s67, s66, 55296
    v_add_u32 v0, 4096, v6
    s_add_u32 s62, s51, 512
    v_lshlrev_b32 v4, 2, v1
    s_mov_b32 s42, 0
    s_mov_b64 exec, -1
L_gd:
    buffer_load_dword v5, v4, s[20:23], s62 offen sc1
    s_add_u32 s42, s42, 1
    s_cmp_gt_u32 s42, 0x100000
    s_cbranch_scc1 L_gdx
    s_waitcnt vmcnt(0)
    v_cmp_eq_u32 vcc, s36, v5
    s_cmp_eq_u64 vcc, exec
    s_cbranch_scc0 L_gd
L_gdx:
    s_mov_b64 exec, -1
    v_mov_b32 v4, 109056
    ds_write_b32 v4, v4
    buffer_load_dwordx4 v[196:199], v6, s[20:23], s64 offen offset:0 sc1
    buffer_load_dwordx4 v[200:203], v6, s[20:23], s64 offen offset:1024 sc1
    buffer_load_dwordx4 v[204:207], v6, s[20:23], s64 offen offset:2048 sc1
    buffer_load_dwordx4 v[208:211], v6, s[20:23], s64 offen offset:3072 sc1
    buffer_load_dwordx4 v[212:215], v0, s[20:23], s64 offen offset:0 sc1
    buffer_load_dwordx4 v[216:219], v0, s[20:23], s64 offen offset:1024 sc1
    buffer_load_dwordx4 v[220:223], v0, s[20:23], s64 offen offset:2048 sc1
    s_waitcnt vmcnt(0)
L_f2:
    s_setprio 1
    s_cmp_lt_u32 s30, 4
    s_cbranch_scc1 L_f2p
    s_setprio 2
L_f2p:
    s_lshl_b32 s32, s30, 5
    s_lshl_b32 s33, s79, 5
    s_sub_u32 s33, s33, 32
    v_lshl_add_u32 v2, v1, 2, s33
    s_mov_b64 exec, 0xff
    v_lshl_add_u32 v2, v1, 2, s32
    s_add_u32 s62, s51, 768
    s_mov_b64 exec, -1
    s_mul_i32 s32, s30, 10240
    v_add_u32 v10, s32, v6
    v_and_b32 v11, 15, v1
    v_mul_u32_u24 v11, 1280, v11
    v_lshrrev_b32 v5, 4, v1
    v_lshl_add_u32 v11, v5, 3, v11
    s_waitcnt vmcnt(8)
    v_mfma_f32_16x16x32_bf16 v[12:15], v[56:59], v[196:199], 0
    v_mfma_f32_16x16x32_bf16 v[16:19], v[60:63], v[196:199], 0
    buffer_load_dwordx4 v[224:227], v6, s[20:23], s65 offen offset:0 sc1
    v_mfma_f32_16x16x32_bf16 v[20:23], v[64:67], v[196:199], 0
    v_mfma_f32_16x16x32_bf16 v[24:27], v[68:71], v[196:199], 0
    buffer_load_dwordx4 v[228:231], v6, s[20:23], s65 offen offset:1024 sc1
    v_mfma_f32_16x16x32_bf16 v[28:31], v[72:75], v[196:199], 0
    s_waitcnt vmcnt(9)
    v_mfma_f32_16x16x32_bf16 v[12:15], v[76:79], v[200:203], v[12:15]
    v_mfma_f32_16x16x32_bf16 v[16:19], v[80:83], v[200:203], v[16:19]
    buffer_load_dwordx4 v[232:235], v6, s[20:23], s65 offen offset:2048 sc1
    v_mfma_f32_16x16x32_bf16 v[20:23], v[84:87], v[200:203], v[20:23]
    v_mfma_f32_16x16x32_bf16 v[24:27], v[88:91], v[200:203], v[24:27]
    buffer_load_dwordx4 v[236:239], v6, s[20:23], s65 offen offset:3072 sc1
    v_mfma_f32_16x16x32_bf16 v[28:31], v[92:95], v[200:203], v[28:31]
    s_waitcnt vmcnt(10)
    v_mfma_f32_16x16x32_bf16 v[12:15], v[96:99], v[204:207], v[12:15]
    v_mfma_f32_16x16x32_bf16 v[16:19], v[100:103], v[204:207], v[16:19]
    buffer_load_dwordx4 v[240:243], v0, s[20:23], s65 offen offset:0 sc1
    v_mfma_f32_16x16x32_bf16 v[20:23], v[104:107], v[204:207], v[20:23]
    v_mfma_f32_16x16x32_bf16 v[24:27], v[108:111], v[204:207], v[24:27]
    buffer_load_dwordx4 v[244:247], v0, s[20:23], s65 offen offset:1024 sc1
    v_mfma_f32_16x16x32_bf16 v[28:31], v[112:115], v[204:207], v[28:31]
    s_waitcnt vmcnt(10)
    v_mfma_f32_16x16x32_bf16 v[12:15], v[116:119], v[208:211], v[12:15]
    v_mfma_f32_16x16x32_bf16 v[16:19], v[120:123], v[208:211], v[16:19]
    buffer_load_dwordx4 v[248:251], v0, s[20:23], s65 offen offset:2048 sc1
    v_mfma_f32_16x16x32_bf16 v[20:23], v[124:127], v[208:211], v[20:23]
    v_mfma_f32_16x16x32_bf16 v[24:27], v[128:131], v[208:211], v[24:27]
    v_mfma_f32_16x16x32_bf16 v[28:31], v[132:135], v[208:211], v[28:31]
    s_waitcnt vmcnt(10)
    v_mfma_f32_16x16x32_bf16 v[12:15], v[136:139], v[212:215], v[12:15]
    v_mfma_f32_16x16x32_bf16 v[16:19], v[140:143], v[212:215], v[16:19]
    v_mfma_f32_16x16x32_bf16 v[20:23], v[144:147], v[212:215], v[20:23]
    v_mfma_f32_16x16x32_bf16 v[24:27], v[148:151], v[212:215], v[24:27]
    v_mfma_f32_16x16x32_bf16 v[28:31], v[152:155], v[212:215], v[28:31]
    s_waitcnt vmcnt(9)
    v_mfma_f32_16x16x32_bf16 v[12:15], v[156:159], v[216:219], v[12:15]
    v_mfma_f32_16x16x32_bf16 v[16:19], v[160:163], v[216:219], v[16:19]
    v_mfma_f32_16x16x32_bf16 v[20:23], v[164:167], v[216:219], v[20:23]
    v_mfma_f32_16x16x32_bf16 v[24:27], v[168:171], v[216:219], v[24:27]
    v_mfma_f32_16x16x32_bf16 v[28:31], v[172:175], v[216:219], v[28:31]
    s_waitcnt vmcnt(8)
    s_cmp_ge_u32 s30, 6
    s_cbranch_scc1 L_sk0
    v_mfma_f32_16x16x32_bf16 v[12:15], v[176:179], v[220:223], v[12:15]
    v_mfma_f32_16x16x32_bf16 v[16:19], v[180:183], v[220:223], v[16:19]
    v_mfma_f32_16x16x32_bf16 v[20:23], v[184:187], v[220:223], v[20:23]
    v_mfma_f32_16x16x32_bf16 v[24:27], v[188:191], v[220:223], v[24:27]
    v_mfma_f32_16x16x32_bf16 v[28:31], v[192:195], v[220:223], v[28:31]
L_sk0:
    v_mov_b32 v4, 0
    v_mov_b32 v5, s36
    s_mov_b64 exec, 1
    s_waitcnt vmcnt(0)
    s_cmp_eq_u32 s72, 0
    s_cbranch_scc1 L_lspz
    buffer_store_dword v5, v4, s[20:23], s6 offen
L_lepz:
    s_mov_b64 exec, -1
    s_load_dwordx4 s[4:7], s[0:1], 56
    v_mfma_f32_16x16x32_bf16 v[32:35], v[56:59], v[224:227], 0
    v_mfma_f32_16x16x32_bf16 v[36:39], v[60:63], v[224:227], 0
    v_mfma_f32_16x16x32_bf16 v[40:43], v[64:67], v[224:227], 0
    v_mfma_f32_16x16x32_bf16 v[44:47], v[68:71], v[224:227], 0
    v_mfma_f32_16x16x32_bf16 v[48:51], v[72:75], v[224:227], 0
    v_mfma_f32_16x16x32_bf16 v[32:35], v[76:79], v[228:231], v[32:35]
    v_mfma_f32_16x16x32_bf16 v[36:39], v[80:83], v[228:231], v[36:39]
    v_mfma_f32_16x16x32_bf16 v[40:43], v[84:87], v[228:231], v[40:43]
    v_mfma_f32_16x16x32_bf16 v[44:47], v[88:91], v[228:231], v[44:47]
    v_mfma_f32_16x16x32_bf16 v[48:51], v[92:95], v[228:231], v[48:51]
    v_mfma_f32_16x16x32_bf16 v[32:35], v[96:99], v[232:235], v[32:35]
    v_mfma_f32_16x16x32_bf16 v[36:39], v[100:103], v[232:235], v[36:39]
    v_mfma_f32_16x16x32_bf16 v[40:43], v[104:107], v[232:235], v[40:43]
    v_mfma_f32_16x16x32_bf16 v[44:47], v[108:111], v[232:235], v[44:47]
    v_mfma_f32_16x16x32_bf16 v[48:51], v[112:115], v[232:235], v[48:51]
    v_mfma_f32_16x16x32_bf16 v[32:35], v[116:119], v[236:239], v[32:35]
    v_mfma_f32_16x16x32_bf16 v[36:39], v[120:123], v[236:239], v[36:39]
    s_mov_b64 exec, 0xffff
    buffer_load_dword v3, v2, s[20:23], s62 offen sc1
    s_mov_b64 exec, -1
    v_mfma_f32_16x16x32_bf16 v[40:43], v[124:127], v[236:239], v[40:43]
    v_mfma_f32_16x16x32_bf16 v[44:47], v[128:131], v[236:239], v[44:47]
    v_mfma_f32_16x16x32_bf16 v[48:51], v[132:135], v[236:239], v[48:51]
    v_mfma_f32_16x16x32_bf16 v[32:35], v[136:139], v[240:243], v[32:35]
    v_mfma_f32_16x16x32_bf16 v[36:39], v[140:143], v[240:243], v[36:39]
    v_mfma_f32_16x16x32_bf16 v[40:43], v[144:147], v[240:243], v[40:43]
    v_mfma_f32_16x16x32_bf16 v[44:47], v[148:151], v[240:243], v[44:47]
    v_mfma_f32_16x16x32_bf16 v[48:51], v[152:155], v[240:243], v[48:51]
    v_mfma_f32_16x16x32_bf16 v[32:35], v[156:159], v[244:247], v[32:35]
    v_mfma_f32_16x16x32_bf16 v[36:39], v[160:163], v[244:247], v[36:39]
    v_mfma_f32_16x16x32_bf16 v[40:43], v[164:167], v[244:247], v[40:43]
    v_mfma_f32_16x16x32_bf16 v[44:47], v[168:171], v[244:247], v[44:47]
    v_mfma_f32_16x16x32_bf16 v[48:51], v[172:175], v[244:247], v[48:51]
    s_cmp_ge_u32 s30, 6
    s_cbranch_scc1 L_sk1
    v_mfma_f32_16x16x32_bf16 v[32:35], v[176:179], v[248:251], v[32:35]
    v_mfma_f32_16x16x32_bf16 v[36:39], v[180:183], v[248:251], v[36:39]
    v_mfma_f32_16x16x32_bf16 v[40:43], v[184:187], v[248:251], v[40:43]
    v_mfma_f32_16x16x32_bf16 v[44:47], v[188:191], v[248:251], v[44:47]
    v_mfma_f32_16x16x32_bf16 v[48:51], v[192:195], v[248:251], v[48:51]
L_sk1:
    s_waitcnt vmcnt(0)
    s_mov_b32 s42, 0
    s_mov_b64 exec, 3855
L_fec:
    v_cmp_eq_u32 vcc, s36, v3
    s_cmp_eq_u64 vcc, exec
    s_cbranch_scc0 L_fel
L_fex:
    s_mov_b64 exec, -1
    buffer_load_dwordx4 v[196:199], v6, s[20:23], s66 offen offset:0 sc1
    ds_write_b128 v10, v[12:15] offset:0
    buffer_load_dwordx4 v[200:203], v6, s[20:23], s67 offen offset:0 sc1
    ds_write_b128 v10, v[16:19] offset:1024
    buffer_load_dwordx4 v[204:207], v6, s[20:23], s66 offen offset:1024 sc1
    ds_write_b128 v10, v[20:23] offset:2048
    buffer_load_dwordx4 v[208:211], v6, s[20:23], s67 offen offset:1024 sc1
    ds_write_b128 v10, v[24:27] offset:3072
    buffer_load_dwordx4 v[212:215], v6, s[20:23], s66 offen offset:2048 sc1
    ds_write_b128 v10, v[28:31] offset:4096
    buffer_load_dwordx4 v[216:219], v6, s[20:23], s67 offen offset:2048 sc1
    ds_write_b128 v10, v[32:35] offset:5120
    buffer_load_dwordx4 v[220:223], v6, s[20:23], s66 offen offset:3072 sc1
    ds_write_b128 v10, v[36:39] offset:6144
    buffer_load_dwordx4 v[224:227], v6, s[20:23], s67 offen offset:3072 sc1
    ds_write_b128 v10, v[40:43] offset:7168
    ds_write_b128 v10, v[44:47] offset:8192
    ds_write_b128 v10, v[48:51] offset:9216
    s_waitcnt lgkmcnt(0)
    s_mov_b32 s16, s4
    s_mov_b32 s17, s5
    s_mov_b32 s18, 1280
    s_mov_b32 s19, 0x00020000
    s_mov_b32 s12, s6
    s_mov_b32 s13, s7
    s_mov_b32 s14, 2621440
    s_mov_b32 s15, 0x00020000
    s_waitcnt vmcnt(7)
    v_mfma_f32_16x16x32_bf16 v[12:15], v[56:59], v[196:199], 0
    v_mfma_f32_16x16x32_bf16 v[16:19], v[60:63], v[196:199], 0
    s_mov_b64 exec, 0xffff
    buffer_load_dword v3, v2, s[20:23], s62 offen sc1
    s_mov_b64 exec, -1
    v_mfma_f32_16x16x32_bf16 v[20:23], v[64:67], v[196:199], 0
    v_mfma_f32_16x16x32_bf16 v[24:27], v[68:71], v[196:199], 0
    v_mfma_f32_16x16x32_bf16 v[28:31], v[72:75], v[196:199], 0
    s_waitcnt vmcnt(7)
    v_mfma_f32_16x16x32_bf16 v[32:35], v[56:59], v[200:203], 0
    v_mfma_f32_16x16x32_bf16 v[36:39], v[60:63], v[200:203], 0
    v_mfma_f32_16x16x32_bf16 v[40:43], v[64:67], v[200:203], 0
    v_mfma_f32_16x16x32_bf16 v[44:47], v[68:71], v[200:203], 0
    v_mfma_f32_16x16x32_bf16 v[48:51], v[72:75], v[200:203], 0
    s_waitcnt vmcnt(6)
    v_mfma_f32_16x16x32_bf16 v[12:15], v[76:79], v[204:207], v[12:15]
    v_mfma_f32_16x16x32_bf16 v[16:19], v[80:83], v[204:207], v[16:19]
    v_mfma_f32_16x16x32_bf16 v[20:23], v[84:87], v[204:207], v[20:23]
    v_mfma_f32_16x16x32_bf16 v[24:27], v[88:91], v[204:207], v[24:27]
    v_mfma_f32_16x16x32_bf16 v[28:31], v[92:95], v[204:207], v[28:31]
    s_waitcnt vmcnt(5)
    v_mfma_f32_16x16x32_bf16 v[32:35], v[76:79], v[208:211], v[32:35]
    v_mfma_f32_16x16x32_bf16 v[36:39], v[80:83], v[208:211], v[36:39]
    v_mfma_f32_16x16x32_bf16 v[40:43], v[84:87], v[208:211], v[40:43]
    v_mfma_f32_16x16x32_bf16 v[44:47], v[88:91], v[208:211], v[44:47]
    v_mfma_f32_16x16x32_bf16 v[48:51], v[92:95], v[208:211], v[48:51]
    s_waitcnt vmcnt(0)
    s_mov_b32 s42, 0
    s_mov_b64 exec, 65520
L_flc:
    v_cmp_eq_u32 vcc, s36, v3
    s_cmp_eq_u64 vcc, exec
    s_cbranch_scc0 L_fll
L_flx:
    s_mov_b64 exec, -1
    v_lshrrev_b32 v2, 4, v1
    v_lshlrev_b32 v2, 3, v2
    s_mul_i32 s62, s79, 5
    s_add_u32 s62, s62, s69
    s_lshl_b32 s62, s62, 5
    v_add_u32 v10, 81920, v10
    v_mfma_f32_16x16x32_bf16 v[12:15], v[96:99], v[212:215], v[12:15]
    buffer_load_dwordx4 v[228:231], v0, s[20:23], s66 offen offset:0 sc1
    v_mfma_f32_16x16x32_bf16 v[16:19], v[100:103], v[212:215], v[16:19]
    v_mfma_f32_16x16x32_bf16 v[20:23], v[104:107], v[212:215], v[20:23]
    buffer_load_dwordx4 v[232:235], v0, s[20:23], s66 offen offset:1024 sc1
    v_mfma_f32_16x16x32_bf16 v[24:27], v[108:111], v[212:215], v[24:27]
    v_mfma_f32_16x16x32_bf16 v[28:31], v[112:115], v[212:215], v[28:31]
    buffer_load_dwordx4 v[236:239], v0, s[20:23], s66 offen offset:2048 sc1
    v_mfma_f32_16x16x32_bf16 v[32:35], v[96:99], v[216:219], v[32:35]
    buffer_load_dwordx4 v[240:243], v0, s[20:23], s67 offen offset:0 sc1
    v_mfma_f32_16x16x32_bf16 v[36:39], v[100:103], v[216:219], v[36:39]
    v_mfma_f32_16x16x32_bf16 v[40:43], v[104:107], v[216:219], v[40:43]
    buffer_load_dwordx4 v[244:247], v0, s[20:23], s67 offen offset:1024 sc1
    v_mfma_f32_16x16x32_bf16 v[44:47], v[108:111], v[216:219], v[44:47]
    v_mfma_f32_16x16x32_bf16 v[48:51], v[112:115], v[216:219], v[48:51]
    buffer_load_dwordx4 v[248:251], v0, s[20:23], s67 offen offset:2048 sc1
    v_mfma_f32_16x16x32_bf16 v[12:15], v[116:119], v[220:223], v[12:15]
    buffer_load_dwordx2 v[252:253], v2, s[16:19], s62 offen offset:0
    v_mfma_f32_16x16x32_bf16 v[16:19], v[120:123], v[220:223], v[16:19]
    v_mfma_f32_16x16x32_bf16 v[20:23], v[124:127], v[220:223], v[20:23]
    buffer_load_dwordx2 v[254:255], v2, s[16:19], s62 offen offset:32
    v_mfma_f32_16x16x32_bf16 v[24:27], v[128:131], v[220:223], v[24:27]
    v_mfma_f32_16x16x32_bf16 v[28:31], v[132:135], v[220:223], v[28:31]
    buffer_load_dwordx2 v[4:5], v2, s[16:19], s62 offen offset:64
    v_mfma_f32_16x16x32_bf16 v[32:35], v[116:119], v[224:227], v[32:35]
    v_mfma_f32_16x16x32_bf16 v[36:39], v[120:123], v[224:227], v[36:39]
    v_mfma_f32_16x16x32_bf16 v[40:43], v[124:127], v[224:227], v[40:43]
    v_mfma_f32_16x16x32_bf16 v[44:47], v[128:131], v[224:227], v[44:47]
    v_mfma_f32_16x16x32_bf16 v[48:51], v[132:135], v[224:227], v[48:51]
    s_waitcnt vmcnt(8)
    v_mfma_f32_16x16x32_bf16 v[12:15], v[136:139], v[228:231], v[12:15]
    v_mfma_f32_16x16x32_bf16 v[16:19], v[140:143], v[228:231], v[16:19]
    v_mfma_f32_16x16x32_bf16 v[20:23], v[144:147], v[228:231], v[20:23]
    v_mfma_f32_16x16x32_bf16 v[24:27], v[148:151], v[228:231], v[24:27]
    v_mfma_f32_16x16x32_bf16 v[28:31], v[152:155], v[228:231], v[28:31]
    s_waitcnt vmcnt(7)
    v_mfma_f32_16x16x32_bf16 v[12:15], v[156:159], v[232:235], v[12:15]
    v_mfma_f32_16x16x32_bf16 v[16:19], v[160:163], v[232:235], v[16:19]
    v_mfma_f32_16x16x32_bf16 v[20:23], v[164:167], v[232:235], v[20:23]
    v_mfma_f32_16x16x32_bf16 v[24:27], v[168:171], v[232:235], v[24:27]
    v_mfma_f32_16x16x32_bf16 v[28:31], v[172:175], v[232:235], v[28:31]
    s_waitcnt vmcnt(6)
    s_cmp_ge_u32 s30, 6
    s_cbranch_scc1 L_sk2
    v_mfma_f32_16x16x32_bf16 v[12:15], v[176:179], v[236:239], v[12:15]
    v_mfma_f32_16x16x32_bf16 v[16:19], v[180:183], v[236:239], v[16:19]
    v_mfma_f32_16x16x32_bf16 v[20:23], v[184:187], v[236:239], v[20:23]
    v_mfma_f32_16x16x32_bf16 v[24:27], v[188:191], v[236:239], v[24:27]
    v_mfma_f32_16x16x32_bf16 v[28:31], v[192:195], v[236:239], v[28:31]
L_sk2:
    s_waitcnt vmcnt(0)
    v_mfma_f32_16x16x32_bf16 v[32:35], v[136:139], v[240:243], v[32:35]
    v_mfma_f32_16x16x32_bf16 v[36:39], v[140:143], v[240:243], v[36:39]
    v_mfma_f32_16x16x32_bf16 v[40:43], v[144:147], v[240:243], v[40:43]
    v_mfma_f32_16x16x32_bf16 v[44:47], v[148:151], v[240:243], v[44:47]
    v_mfma_f32_16x16x32_bf16 v[48:51], v[152:155], v[240:243], v[48:51]
    ds_write_b128 v10, v[12:15] offset:0
    v_mfma_f32_16x16x32_bf16 v[32:35], v[156:159], v[244:247], v[32:35]
    ds_write_b128 v10, v[16:19] offset:1024
    v_mfma_f32_16x16x32_bf16 v[36:39], v[160:163], v[244:247], v[36:39]
    ds_write_b128 v10, v[20:23] offset:2048
    v_mfma_f32_16x16x32_bf16 v[40:43], v[164:167], v[244:247], v[40:43]
    ds_write_b128 v10, v[24:27] offset:3072
    v_mfma_f32_16x16x32_bf16 v[44:47], v[168:171], v[244:247], v[44:47]
    ds_write_b128 v10, v[28:31] offset:4096
    v_mfma_f32_16x16x32_bf16 v[48:51], v[172:175], v[244:247], v[48:51]
    s_cmp_ge_u32 s30, 6
    s_cbranch_scc1 L_sk3
    v_mfma_f32_16x16x32_bf16 v[32:35], v[176:179], v[248:251], v[32:35]
    v_mfma_f32_16x16x32_bf16 v[36:39], v[180:183], v[248:251], v[36:39]
    v_mfma_f32_16x16x32_bf16 v[40:43], v[184:187], v[248:251], v[40:43]
    v_mfma_f32_16x16x32_bf16 v[44:47], v[188:191], v[248:251], v[44:47]
    v_mfma_f32_16x16x32_bf16 v[48:51], v[192:195], v[248:251], v[48:51]
L_sk3:
    s_lshr_b32 s32, s30, 2
    s_mul_i32 s32, s32, 81920
    s_add_u32 s32, s32, s70
    v_add_u32 v2, s32, v6
    v_add_u32 v3, 40960, v2
    s_nop 2
    ds_write_b128 v10, v[32:35] offset:5120
    ds_write_b128 v10, v[36:39] offset:6144
    ds_write_b128 v10, v[40:43] offset:7168
    ds_write_b128 v10, v[44:47] offset:8192
    ds_write_b128 v10, v[48:51] offset:9216
    s_waitcnt lgkmcnt(0)
    s_barrier
    ds_read_b128 v[64:67], v2 offset:0
    ds_read_b128 v[68:71], v2 offset:10240
    ds_read_b128 v[72:75], v2 offset:20480
    ds_read_b128 v[76:79], v2 offset:30720
    ds_read_b128 v[80:83], v3 offset:0
    ds_read_b128 v[84:87], v3 offset:10240
    ds_read_b128 v[88:91], v3 offset:20480
    ds_read_b128 v[92:95], v3 offset:30720
    ds_read_b128 v[96:99], v2 offset:1024
    ds_read_b128 v[100:103], v2 offset:11264
    ds_read_b128 v[104:107], v2 offset:21504
    ds_read_b128 v[108:111], v2 offset:31744
    ds_read_b128 v[112:115], v3 offset:1024
    ds_read_b128 v[116:119], v3 offset:11264
    ds_read_b128 v[120:123], v3 offset:21504
    ds_read_b128 v[124:127], v3 offset:31744
    s_waitcnt lgkmcnt(11)
    v_pk_add_f32 v[64:65], v[64:65], v[80:81]
    v_pk_add_f32 v[66:67], v[66:67], v[82:83]
    s_waitcnt lgkmcnt(10)
    v_pk_add_f32 v[68:69], v[68:69], v[84:85]
    v_pk_add_f32 v[70:71], v[70:71], v[86:87]
    s_waitcnt lgkmcnt(9)
    v_pk_add_f32 v[72:73], v[72:73], v[88:89]
    v_pk_add_f32 v[74:75], v[74:75], v[90:91]
    s_waitcnt lgkmcnt(8)
    v_pk_add_f32 v[76:77], v[76:77], v[92:93]
    v_pk_add_f32 v[78:79], v[78:79], v[94:95]
    v_pk_add_f32 v[64:65], v[64:65], v[72:73]
    v_pk_add_f32 v[66:67], v[66:67], v[74:75]
    v_pk_add_f32 v[68:69], v[68:69], v[76:77]
    v_pk_add_f32 v[70:71], v[70:71], v[78:79]
    v_pk_add_f32 v[64:65], v[64:65], v[68:69]
    v_pk_add_f32 v[66:67], v[66:67], v[70:71]
    v_lshlrev_b32 v44, 16, v252
    v_and_b32 v45, 0xffff0000, v252
    v_lshlrev_b32 v46, 16, v253
    v_and_b32 v47, 0xffff0000, v253
    v_pk_add_f32 v[64:65], v[64:65], v[44:45]
    v_pk_add_f32 v[66:67], v[66:67], v[46:47]
    v_lshlrev_b32 v44, 16, v52
    v_and_b32 v45, 0xffff0000, v52
    v_lshlrev_b32 v46, 16, v53
    v_and_b32 v47, 0xffff0000, v53
    v_pk_add_f32 v[64:65], v[64:65], v[44:45]
    v_pk_add_f32 v[66:67], v[66:67], v[46:47]
    v_cvt_pk_bf16_f32 v52, v64, v65
    v_cvt_pk_bf16_f32 v53, v66, v67
    buffer_store_dwordx2 v[52:53], v11, s[12:15], s74 offen offset:0
    ds_read_b128 v[128:131], v2 offset:2048
    ds_read_b128 v[132:135], v2 offset:12288
    ds_read_b128 v[136:139], v2 offset:22528
    ds_read_b128 v[140:143], v2 offset:32768
    ds_read_b128 v[144:147], v3 offset:2048
    ds_read_b128 v[148:151], v3 offset:12288
    ds_read_b128 v[152:155], v3 offset:22528
    ds_read_b128 v[156:159], v3 offset:32768
    s_waitcnt lgkmcnt(11)
    v_pk_add_f32 v[96:97], v[96:97], v[112:113]
    v_pk_add_f32 v[98:99], v[98:99], v[114:115]
    s_waitcnt lgkmcnt(10)
    v_pk_add_f32 v[100:101], v[100:101], v[116:117]
    v_pk_add_f32 v[102:103], v[102:103], v[118:119]
    s_waitcnt lgkmcnt(9)
    v_pk_add_f32 v[104:105], v[104:105], v[120:121]
    v_pk_add_f32 v[106:107], v[106:107], v[122:123]
    s_waitcnt lgkmcnt(8)
    v_pk_add_f32 v[108:109], v[108:109], v[124:125]
    v_pk_add_f32 v[110:111], v[110:111], v[126:127]
    v_pk_add_f32 v[96:97], v[96:97], v[104:105]
    v_pk_add_f32 v[98:99], v[98:99], v[106:107]
    v_pk_add_f32 v[100:101], v[100:101], v[108:109]
    v_pk_add_f32 v[102:103], v[102:103], v[110:111]
    v_pk_add_f32 v[96:97], v[96:97], v[100:101]
    v_pk_add_f32 v[98:99], v[98:99], v[102:103]
    v_lshlrev_b32 v44, 16, v254
    v_and_b32 v45, 0xffff0000, v254
    v_lshlrev_b32 v46, 16, v255
    v_and_b32 v47, 0xffff0000, v255
    v_pk_add_f32 v[96:97], v[96:97], v[44:45]
    v_pk_add_f32 v[98:99], v[98:99], v[46:47]
    v_lshlrev_b32 v44, 16, v54
    v_and_b32 v45, 0xffff0000, v54
    v_lshlrev_b32 v46, 16, v55
    v_and_b32 v47, 0xffff0000, v55
    v_pk_add_f32 v[96:97], v[96:97], v[44:45]
    v_pk_add_f32 v[98:99], v[98:99], v[46:47]
    v_cvt_pk_bf16_f32 v54, v96, v97
    v_cvt_pk_bf16_f32 v55, v98, v99
    buffer_store_dwordx2 v[54:55], v11, s[12:15], s74 offen offset:32
    s_cmp_lg_u32 s69, 0
    s_cbranch_scc1 L_rew2
    s_waitcnt lgkmcnt(3)
    v_pk_add_f32 v[128:129], v[128:129], v[144:145]
    v_pk_add_f32 v[130:131], v[130:131], v[146:147]
    s_waitcnt lgkmcnt(2)
    v_pk_add_f32 v[132:133], v[132:133], v[148:149]
    v_pk_add_f32 v[134:135], v[134:135], v[150:151]
    s_waitcnt lgkmcnt(1)
    v_pk_add_f32 v[136:137], v[136:137], v[152:153]
    v_pk_add_f32 v[138:139], v[138:139], v[154:155]
    s_waitcnt lgkmcnt(0)
    v_pk_add_f32 v[140:141], v[140:141], v[156:157]
    v_pk_add_f32 v[142:143], v[142:143], v[158:159]
    v_pk_add_f32 v[128:129], v[128:129], v[136:137]
    v_pk_add_f32 v[130:131], v[130:131], v[138:139]
    v_pk_add_f32 v[132:133], v[132:133], v[140:141]
    v_pk_add_f32 v[134:135], v[134:135], v[142:143]
    v_pk_add_f32 v[128:129], v[128:129], v[132:133]
    v_pk_add_f32 v[130:131], v[130:131], v[134:135]
    v_lshlrev_b32 v44, 16, v4
    v_and_b32 v45, 0xffff0000, v4
    v_lshlrev_b32 v46, 16, v5
    v_and_b32 v47, 0xffff0000, v5
    v_pk_add_f32 v[128:129], v[128:129], v[44:45]
    v_pk_add_f32 v[130:131], v[130:131], v[46:47]
    v_lshlrev_b32 v44, 16, v8
    v_and_b32 v45, 0xffff0000, v8
    v_lshlrev_b32 v46, 16, v9
    v_and_b32 v47, 0xffff0000, v9
    v_pk_add_f32 v[128:129], v[128:129], v[44:45]
    v_pk_add_f32 v[130:131], v[130:131], v[46:47]
    v_cvt_pk_bf16_f32 v8, v128, v129
    v_cvt_pk_bf16_f32 v9, v130, v131
    buffer_store_dwordx2 v[8:9], v11, s[12:15], s74 offen offset:64
L_rew2:
    s_or_b32 s32, s2, s30
    s_cmp_lg_u32 s32, 0
    s_cbranch_scc1 L_ne
    v_mov_b32 v4, 0
    v_mov_b32 v5, s36
    s_mov_b32 s32, 32505856
    s_mov_b64 exec, 1
    buffer_store_dword v5, v4, s[20:23], s32 offen sc1
    s_mov_b64 exec, -1
L_ne:
    s_branch L_sequential_preLN__softmax_full_mha__dense_activation_gelu__prompt_kernel_end
L_vf:
    s_setprio 0
    s_load_dwordx2 s[4:5], s[0:1], 0
    s_load_dwordx2 s[6:7], s[0:1], 40
    s_getreg_b32 s60, hwreg(HW_REG_XCC_ID, 0, 4)
    s_and_b32 s56, s28, 3
    s_lshr_b32 s79, s28, 2
    s_cmp_ge_u32 s79, 6
    s_cselect_b32 s57, 6, 7
    s_mul_i32 s32, s79, 7
    s_cmp_eq_u32 s79, 7
    s_cselect_b32 s32, 48, s32
    s_add_u32 s58, s32, s30
    s_min_u32 s58, s58, 53
    s_xor_b32 s40, s30, 4
    s_add_u32 s40, s40, s32
    s_min_u32 s40, s40, 53
    s_mul_i32 s68, s30, 7
    s_min_u32 s68, s68, 48
    s_mul_i32 s62, s31, 7
    s_add_u32 s62, s62, 28
    s_min_u32 s62, s62, 48
    s_mul_i32 s39, s58, 40960
    s_add_u32 s39, s39, 16777216
    s_mul_i32 s37, s40, 40960
    s_add_u32 s37, s37, 16777216
    s_mul_i32 s32, s79, 54
    s_add_u32 s41, s32, s68
    s_mul_i32 s41, s41, 5120
    s_add_u32 s41, s41, 19136512
    s_add_u32 s38, s32, s62
    s_mul_i32 s38, s38, 5120
    s_add_u32 s38, s38, 19136512
    s_add_u32 s32, s32, 160
    s_setprio 3
    v_and_b32 v2, 7, v1
    v_add_u32 v3, s62, v2
    s_mov_b64 exec, 0xffffffff
    v_add_u32 v3, s68, v2
    s_mov_b64 exec, -1
    v_min_u32 v3, 53, v3
    v_add_u32 v4, s32, v3
    s_lshl_b32 s32, s40, 3
    s_add_u32 s32, s32, 592
    s_mov_b64 exec, 0xffffff
    v_add_u32 v4, s32, v2
    s_lshl_b32 s32, s58, 3
    s_add_u32 s32, s32, 592
    s_mov_b64 exec, 0xffff
    v_add_u32 v4, s32, v2
    s_setprio 0
    s_mul_i32 s32, s79, 20
    s_add_u32 s33, s32, s31
    s_add_u32 s33, s33, 16
    s_mov_b64 exec, 0xff
    s_setprio 3
    v_mov_b32 v4, s33
    s_lshl_b32 s34, s31, 2
    s_add_u32 s32, s32, s34
    s_mov_b64 exec, 15
    v_add_u32 v4, s32, v2
    s_setprio 0
    s_mov_b64 exec, -1
    s_mul_i32 s76, s32, 5120
    s_add_u32 s76, s76, 15728640
    s_mul_i32 s77, s33, 5120
    s_add_u32 s77, s77, 15728640
    s_setprio 3
    v_lshlrev_b32 v4, 2, v4
    v_and_b32 v2, 31, v1
    v_lshlrev_b32 v2, 2, v2
    s_setprio 0
    s_mov_b32 s34, 32538624
    s_lshl_b32 s62, s29, 7
    s_add_u32 s62, s62, 32542720
    s_mov_b32 s42, 0
L_vp:
    s_setprio 0
    buffer_load_dword v5, v4, s[20:23], s34 offen sc1
    buffer_load_dword v3, v2, s[20:23], s62 offen sc1
    s_add_u32 s42, s42, 1
    s_cmp_gt_u32 s42, 0x100000
    s_cbranch_scc1 L_vpx
    s_waitcnt vmcnt(0)
    s_setprio 3
    v_xor_b32 v5, s36, v5
    v_xor_b32 v3, s36, v3
    v_or_b32 v5, v5, v3
    v_cmp_gt_u32 vcc, 16, v5
    s_setprio 0
    s_cmp_eq_u64 vcc, exec
    s_cbranch_scc1 L_vpx
    s_sleep 8
    s_branch L_vp
L_vpx:
    s_setprio 3
    v_cmp_eq_u32 vcc, s60, v3
    s_setprio 0
    s_cmp_eq_u64 vcc, exec
    s_cselect_b32 s72, 1, 0
    s_mov_b32 s101, 0
    s_lshl_b32 s63, s29, 2
    s_add_u32 s63, s63, s56
    s_lshl_b32 s51, s63, 10
    s_add_u32 s51, s51, 32604160
    s_lshl_b32 s61, s79, 3
    s_add_u32 s61, s61, s30
    s_lshl_b32 s61, s61, 2
    s_add_u32 s61, s61, s51
    s_lshr_b32 s32, s30, 2
    s_lshr_b32 s33, s31, 1
    s_xor_b32 s62, s32, s33
    s_mul_i32 s69, s62, 3
    s_and_b32 s34, s31, 1
    s_mul_i32 s70, s34, 5
    s_add_u32 s70, s70, s69
    s_lshl_b32 s70, s70, 10
    s_lshl_b32 s32, s32, 5
    s_add_u32 s71, s32, s63
    s_mul_i32 s33, s79, 5
    s_add_u32 s33, s33, s69
    s_mul_i32 s73, s71, 40
    s_add_u32 s73, s73, s33
    s_lshl_b32 s73, s73, 2
    s_add_u32 s73, s73, s34
    s_lshl_b32 s73, s73, 8
    s_add_u32 s73, s73, 21495808
    s_lshl_b32 s32, s71, 1
    s_add_u32 s32, s32, s34
    s_mul_i32 s74, s32, 20480
    s_lshl_b32 s33, s33, 5
    s_add_u32 s74, s74, s33
    s_lshl_b32 s75, s32, 4
    s_lshl_b32 s33, s79, 1
    s_add_u32 s75, s75, s33
    s_add_u32 s75, s75, s62
    s_lshl_b32 s75, s75, 7
    s_add_u32 s75, s75, 24117248
    s_waitcnt lgkmcnt(0)
    s_mov_b32 s12, s4
    s_mov_b32 s13, s5
    s_mov_b32 s14, 2621440
    s_mov_b32 s15, 0x00020000
    s_mov_b32 s16, s6
    s_mov_b32 s17, s7
    s_mov_b32 s18, 3456
    s_mov_b32 s19, 0x00020000
    s_setpc_b64 s[52:53]
L_cw:
    s_mov_b32 s10, 0
    s_mov_b32 s11, -1
    s_mov_b64 exec, s[10:11]
    v_mov_b32 v85, v108
    v_mov_b32 v101, v124
    s_mov_b64 exec, -1
    v_add_u32 v10, s50, v6
    v_add_u32 v2, s78, v6
    s_bitcmp0_b32 s30, 0
    s_cbranch_scc1 L_xa
    ds_write_b128 v2, v[76:79]
    v_add_u32 v2, s59, v2
    ds_write_b128 v2, v[80:83]
    v_add_u32 v2, s59, v2
    ds_write_b128 v2, v[84:87]
    s_movk_i32 s59, 1024
    v_mov_b32 v76, v92
    v_mov_b32 v77, v93
    v_mov_b32 v78, v94
    v_mov_b32 v79, v95
    v_mov_b32 v80, v96
    v_mov_b32 v81, v97
    v_mov_b32 v82, v98
    v_mov_b32 v83, v99
    v_mov_b32 v84, v100
    v_mov_b32 v85, v101
    v_mov_b32 v86, v102
    v_mov_b32 v87, v103
    s_setpc_b64 s[52:53]
L_xa:
    ds_write_b128 v2, v[92:95] offset:0
    ds_write_b128 v2, v[96:99] offset:1024
    ds_write_b128 v2, v[100:103] offset:2048
    s_setpc_b64 s[52:53]
L_cf:
    v_add_u32 v2, s59, v10
    v_add_u32 v3, s59, v2
    ds_read_b128 v[116:119], v3
    ds_read_b128 v[108:111], v10
    ds_read_b128 v[112:115], v2
    v_and_b32 v4, 15, v1
    v_lshlrev_b32 v4, 4, v4
    v_bfe_u32 v5, v1, 4, 1
    v_mul_u32_u24 v5, 20480, v5
    v_lshrrev_b32 v2, 5, v1
    v_lshlrev_b32 v2, 8, v2
    v_add3_u32 v2, v2, v4, v5
    v_lshrrev_b32 v4, 1, v4
    v_add_u32 v3, v4, v5
    s_lshl_b32 s32, s100, 2
    s_add_u32 s62, s32, s31
    s_lshr_b32 s33, s30, 2
    s_lshl_b32 s33, s33, 5
    s_add_u32 s32, s62, s33
    s_mul_i32 s32, s32, 40960
    s_add_u32 s32, s32, 13107200
    s_add_u32 s33, s33, s3
    s_lshl_b32 s33, s33, 7
    s_lshl_b32 s62, s62, 13
    s_add_u32 s62, s62, s33
    s_add_u32 s62, s62, 33226752
    s_lshl_b32 s33, s3, 7
    s_add_u32 s33, s33, s32
    s_add_u32 s33, s33, 16384
    s_lshl_b32 s34, s3, 9
    s_add_u32 s32, s32, s34
    s_waitcnt lgkmcnt(2)
    v_min_f32 v124, v85, v117
    v_sub_f32 v125, v124, v85
    v_sub_f32 v127, v124, v117
    v_exp_f32 v125, v125
    v_exp_f32 v127, v127
    s_nop 0
    v_mul_f32 v128, v84, v125
    v_fmac_f32 v128, v116, v127
    v_rcp_f32 v128, v128
    s_nop 0
    v_mul_f32 v125, v125, v128
    v_mul_f32 v127, v127, v128
    v_mov_b32 v124, v125
    v_mov_b32 v126, v127
    s_nop 1
    v_permlane32_swap_b32 v124, v125
    v_permlane32_swap_b32 v126, v127
    s_waitcnt lgkmcnt(0)
    v_mul_f32 v76, v76, v125
    v_mul_f32 v77, v77, v125
    v_mul_f32 v78, v78, v125
    v_mul_f32 v79, v79, v125
    v_mul_f32 v80, v80, v125
    v_mul_f32 v81, v81, v125
    v_mul_f32 v82, v82, v125
    v_mul_f32 v83, v83, v125
    v_mul_f32 v84, v84, v125
    v_mul_f32 v85, v85, v125
    v_mul_f32 v86, v86, v125
    v_mul_f32 v87, v87, v125
    v_fmac_f32 v76, v108, v127
    v_fmac_f32 v77, v109, v127
    v_fmac_f32 v78, v110, v127
    v_fmac_f32 v79, v111, v127
    v_fmac_f32 v80, v112, v127
    v_fmac_f32 v81, v113, v127
    v_fmac_f32 v82, v114, v127
    v_fmac_f32 v83, v115, v127
    v_fmac_f32 v84, v116, v127
    v_fmac_f32 v85, v117, v127
    v_fmac_f32 v86, v118, v127
    v_fmac_f32 v87, v119, v127
    v_cvt_pk_bf16_f32 v76, v76, v77
    v_cvt_pk_bf16_f32 v77, v78, v79
    v_cvt_pk_bf16_f32 v78, v80, v81
    v_cvt_pk_bf16_f32 v79, v82, v83
    v_cvt_pk_bf16_f32 v80, v84, v85
    v_cvt_pk_bf16_f32 v81, v86, v87
    buffer_store_dwordx4 v[76:79], v2, s[20:23], s32 offen sc1
    s_mov_b64 exec, 0xffffffff
    buffer_store_dwordx2 v[80:81], v3, s[20:23], s33 offen sc1
    v_mov_b32 v4, 0
    v_mov_b32 v5, s36
    s_mov_b64 exec, 1
    s_waitcnt vmcnt(0)
    buffer_store_dword v5, v4, s[20:23], s62 offen sc1
    s_mov_b64 exec, -1
    s_setpc_b64 s[52:53]
L_wo:
    s_lshl_b32 s62, s63, 3
    s_add_u32 s62, s62, s30
    s_lshl_b32 s62, s62, 10
    s_add_u32 s62, s62, 33226752
    v_lshlrev_b32 v4, 7, v1
    s_mul_i32 s64, s71, 40960
    s_add_u32 s64, s64, 13107200
    s_lshl_b32 s32, s31, 10
    s_add_u32 s66, s64, s32
    s_add_u32 s66, s66, 16384
    s_lshl_b32 s32, s31, 12
    s_add_u32 s64, s64, s32
    s_add_u32 s65, s64, 20480
    s_add_u32 s67, s66, 20480
    s_mul_i32 s32, s31, 10240
    s_add_u32 s32, s32, s54
    v_add_u32 v10, s32, v6
    v_and_b32 v2, 15, v1
    v_mul_u32_u24 v2, 1280, v2
    v_lshrrev_b32 v5, 4, v1
    v_lshl_add_u32 v2, v5, 3, v2
    s_add_u32 s10, s8, s62
    s_addc_u32 s11, s9, 0
    s_mov_b32 s42, 0
L_go:
    s_load_dword s4, s[10:11], 0 glc
    s_load_dword s5, s[10:11], 128 glc
    s_load_dword s6, s[10:11], 256 glc
    s_load_dword s7, s[10:11], 384 glc
    s_load_dword s24, s[10:11], 512 glc
    s_load_dword s25, s[10:11], 640 glc
    s_load_dword s26, s[10:11], 768 glc
    s_load_dword s27, s[10:11], 896 glc
    s_add_u32 s42, s42, 1
    s_cmp_gt_u32 s42, 0x100000
    s_cbranch_scc1 L_gox
    s_waitcnt lgkmcnt(0)
    s_xor_b32 s4, s4, s36
    s_xor_b32 s5, s5, s36
    s_xor_b32 s6, s6, s36
    s_xor_b32 s7, s7, s36
    s_xor_b32 s24, s24, s36
    s_xor_b32 s25, s25, s36
    s_xor_b32 s26, s26, s36
    s_xor_b32 s27, s27, s36
    s_or_b64 s[4:5], s[4:5], s[6:7]
    s_or_b64 s[24:25], s[24:25], s[26:27]
    s_or_b64 s[4:5], s[4:5], s[24:25]
    s_cbranch_scc1 L_go
L_gox:
    s_waitcnt lgkmcnt(0)
    buffer_load_dwordx4 v[56:59], v6, s[20:23], s64 offen offset:0 sc1
    buffer_load_dwordx4 v[60:63], v6, s[20:23], s64 offen offset:1024 sc1
    buffer_load_dwordx4 v[64:67], v6, s[20:23], s64 offen offset:2048 sc1
    buffer_load_dwordx4 v[68:71], v6, s[20:23], s64 offen offset:3072 sc1
    buffer_load_dwordx2 v[72:73], v7, s[20:23], s66 offen offset:0 sc1
    buffer_load_dwordx2 v[74:75], v7, s[20:23], s66 offen offset:512 sc1
    buffer_load_dwordx4 v[76:79], v6, s[20:23], s65 offen offset:0 sc1
    buffer_load_dwordx4 v[80:83], v6, s[20:23], s65 offen offset:1024 sc1
    buffer_load_dwordx4 v[84:87], v6, s[20:23], s65 offen offset:2048 sc1
    buffer_load_dwordx4 v[88:91], v6, s[20:23], s65 offen offset:3072 sc1
    buffer_load_dwordx2 v[92:93], v7, s[20:23], s67 offen offset:0 sc1
    buffer_load_dwordx2 v[94:95], v7, s[20:23], s67 offen offset:512 sc1
    buffer_load_dwordx2 v[52:53], v2, s[12:15], s74 offen offset:0
    buffer_load_dwordx2 v[54:55], v2, s[12:15], s74 offen offset:32
    buffer_load_dwordx2 v[8:9], v2, s[12:15], s74 offen offset:64
    v_and_b32 v11, 15, v1
    v_lshlrev_b32 v11, 4, v11
    v_bfe_u32 v5, v1, 4, 1
    v_lshl_add_u32 v11, v5, 3, v11
    v_lshrrev_b32 v5, 5, v1
    v_lshl_add_u32 v11, v5, 9, v11
    s_setprio 3
    s_cmp_ge_u32 s30, 4
    s_cbranch_scc1 L_wp1
    s_setprio 2
L_wp1:
    s_waitcnt vmcnt(14)
    v_mfma_f32_16x16x32_bf16 v[12:15], v[156:159], v[56:59], 0
    v_mfma_f32_16x16x32_bf16 v[16:19], v[160:163], v[56:59], 0
    v_mfma_f32_16x16x32_bf16 v[20:23], v[164:167], v[56:59], 0
    v_mfma_f32_16x16x32_bf16 v[24:27], v[168:171], v[56:59], 0
    v_mfma_f32_16x16x32_bf16 v[28:31], v[172:175], v[56:59], 0
    s_waitcnt vmcnt(13)
    v_mfma_f32_16x16x32_bf16 v[12:15], v[176:179], v[60:63], v[12:15]
    v_mfma_f32_16x16x32_bf16 v[16:19], v[180:183], v[60:63], v[16:19]
    v_mfma_f32_16x16x32_bf16 v[20:23], v[184:187], v[60:63], v[20:23]
    v_mfma_f32_16x16x32_bf16 v[24:27], v[188:191], v[60:63], v[24:27]
    v_mfma_f32_16x16x32_bf16 v[28:31], v[192:195], v[60:63], v[28:31]
    s_waitcnt vmcnt(12)
    v_mfma_f32_16x16x32_bf16 v[12:15], v[196:199], v[64:67], v[12:15]
    v_mfma_f32_16x16x32_bf16 v[16:19], v[200:203], v[64:67], v[16:19]
    v_mfma_f32_16x16x32_bf16 v[20:23], v[204:207], v[64:67], v[20:23]
    v_mfma_f32_16x16x32_bf16 v[24:27], v[208:211], v[64:67], v[24:27]
    v_mfma_f32_16x16x32_bf16 v[28:31], v[212:215], v[64:67], v[28:31]
    s_waitcnt vmcnt(11)
    v_mfma_f32_16x16x32_bf16 v[12:15], v[216:219], v[68:71], v[12:15]
    v_mfma_f32_16x16x32_bf16 v[16:19], v[220:223], v[68:71], v[16:19]
    v_mfma_f32_16x16x32_bf16 v[20:23], v[224:227], v[68:71], v[20:23]
    v_mfma_f32_16x16x32_bf16 v[24:27], v[228:231], v[68:71], v[24:27]
    v_mfma_f32_16x16x32_bf16 v[28:31], v[232:235], v[68:71], v[28:31]
    s_waitcnt vmcnt(9)
    v_mfma_f32_16x16x32_bf16 v[12:15], v[236:239], v[72:75], v[12:15]
    v_mfma_f32_16x16x32_bf16 v[16:19], v[240:243], v[72:75], v[16:19]
    v_mfma_f32_16x16x32_bf16 v[20:23], v[244:247], v[72:75], v[20:23]
    v_mfma_f32_16x16x32_bf16 v[24:27], v[248:251], v[72:75], v[24:27]
    v_mfma_f32_16x16x32_bf16 v[28:31], v[252:255], v[72:75], v[28:31]
    s_waitcnt vmcnt(8)
    v_mfma_f32_16x16x32_bf16 v[32:35], v[156:159], v[76:79], 0
    v_mfma_f32_16x16x32_bf16 v[36:39], v[160:163], v[76:79], 0
    v_mfma_f32_16x16x32_bf16 v[40:43], v[164:167], v[76:79], 0
    v_mfma_f32_16x16x32_bf16 v[44:47], v[168:171], v[76:79], 0
    v_mfma_f32_16x16x32_bf16 v[48:51], v[172:175], v[76:79], 0
    ds_write_b128 v10, v[12:15] offset:0
    s_waitcnt vmcnt(7)
    v_mfma_f32_16x16x32_bf16 v[32:35], v[176:179], v[80:83], v[32:35]
    v_mfma_f32_16x16x32_bf16 v[36:39], v[180:183], v[80:83], v[36:39]
    v_mfma_f32_16x16x32_bf16 v[40:43], v[184:187], v[80:83], v[40:43]
    v_mfma_f32_16x16x32_bf16 v[44:47], v[188:191], v[80:83], v[44:47]
    v_mfma_f32_16x16x32_bf16 v[48:51], v[192:195], v[80:83], v[48:51]
    ds_write_b128 v10, v[16:19] offset:1024
    s_waitcnt vmcnt(6)
    v_mfma_f32_16x16x32_bf16 v[32:35], v[196:199], v[84:87], v[32:35]
    v_mfma_f32_16x16x32_bf16 v[36:39], v[200:203], v[84:87], v[36:39]
    v_mfma_f32_16x16x32_bf16 v[40:43], v[204:207], v[84:87], v[40:43]
    v_mfma_f32_16x16x32_bf16 v[44:47], v[208:211], v[84:87], v[44:47]
    v_mfma_f32_16x16x32_bf16 v[48:51], v[212:215], v[84:87], v[48:51]
    ds_write_b128 v10, v[20:23] offset:2048
    s_waitcnt vmcnt(5)
    v_mfma_f32_16x16x32_bf16 v[32:35], v[216:219], v[88:91], v[32:35]
    v_mfma_f32_16x16x32_bf16 v[36:39], v[220:223], v[88:91], v[36:39]
    v_mfma_f32_16x16x32_bf16 v[40:43], v[224:227], v[88:91], v[40:43]
    v_mfma_f32_16x16x32_bf16 v[44:47], v[228:231], v[88:91], v[44:47]
    v_mfma_f32_16x16x32_bf16 v[48:51], v[232:235], v[88:91], v[48:51]
    ds_write_b128 v10, v[24:27] offset:3072
    s_waitcnt vmcnt(3)
    v_mfma_f32_16x16x32_bf16 v[32:35], v[236:239], v[92:95], v[32:35]
    v_mfma_f32_16x16x32_bf16 v[36:39], v[240:243], v[92:95], v[36:39]
    v_mfma_f32_16x16x32_bf16 v[40:43], v[244:247], v[92:95], v[40:43]
    v_mfma_f32_16x16x32_bf16 v[44:47], v[248:251], v[92:95], v[44:47]
    v_mfma_f32_16x16x32_bf16 v[48:51], v[252:255], v[92:95], v[48:51]
    ds_write_b128 v10, v[28:31] offset:4096
    s_nop 2
    ds_write_b128 v10, v[32:35] offset:5120
    ds_write_b128 v10, v[36:39] offset:6144
    ds_write_b128 v10, v[40:43] offset:7168
    ds_write_b128 v10, v[44:47] offset:8192
    ds_write_b128 v10, v[48:51] offset:9216
    s_waitcnt vmcnt(0)
    s_setpc_b64 s[52:53]
L_rw:
    s_add_u32 s32, s54, s70
    v_add_u32 v2, s32, v6
    ds_read_b128 v[12:15], v2 offset:0
    ds_read_b128 v[16:19], v2 offset:10240
    ds_read_b128 v[20:23], v2 offset:20480
    ds_read_b128 v[24:27], v2 offset:30720
    ds_read_b128 v[28:31], v2 offset:1024
    ds_read_b128 v[32:35], v2 offset:11264
    ds_read_b128 v[36:39], v2 offset:21504
    ds_read_b128 v[40:43], v2 offset:31744
    ds_read_b128 v[56:59], v2 offset:2048
    ds_read_b128 v[60:63], v2 offset:12288
    ds_read_b128 v[64:67], v2 offset:22528
    ds_read_b128 v[68:71], v2 offset:32768
    v_mov_b32 v48, 0
    v_mov_b32 v49, 0
    v_mov_b32 v50, 0x3f803f80
    s_waitcnt lgkmcnt(9)
    v_add_f32 v12, v12, v20
    v_add_f32 v13, v13, v21
    v_add_f32 v14, v14, v22
    v_add_f32 v15, v15, v23
    s_waitcnt lgkmcnt(8)
    v_add_f32 v16, v16, v24
    v_add_f32 v17, v17, v25
    v_add_f32 v18, v18, v26
    v_add_f32 v19, v19, v27
    v_add_f32 v12, v12, v16
    v_add_f32 v13, v13, v17
    v_add_f32 v14, v14, v18
    v_add_f32 v15, v15, v19
    v_lshlrev_b32 v44, 16, v52
    v_and_b32 v45, 0xffff0000, v52
    v_lshlrev_b32 v46, 16, v53
    v_and_b32 v47, 0xffff0000, v53
    v_add_f32 v12, v12, v44
    v_add_f32 v13, v13, v45
    v_add_f32 v14, v14, v46
    v_add_f32 v15, v15, v47
    v_cvt_pk_bf16_f32 v52, v12, v13
    v_cvt_pk_bf16_f32 v53, v14, v15
    s_cmp_eq_u32 s72, 0
    s_cbranch_scc1 L_lsh0
    buffer_store_dwordx2 v[52:53], v11, s[20:23], s73 offen offset:0
L_leh0:
    v_add_f32 v48, v48, v12
    v_fmac_f32 v49, v12, v12
    v_add_f32 v48, v48, v13
    v_fmac_f32 v49, v13, v13
    v_add_f32 v48, v48, v14
    v_fmac_f32 v49, v14, v14
    v_add_f32 v48, v48, v15
    v_fmac_f32 v49, v15, v15
    s_waitcnt lgkmcnt(5)
    v_add_f32 v28, v28, v36
    v_add_f32 v29, v29, v37
    v_add_f32 v30, v30, v38
    v_add_f32 v31, v31, v39
    s_waitcnt lgkmcnt(4)
    v_add_f32 v32, v32, v40
    v_add_f32 v33, v33, v41
    v_add_f32 v34, v34, v42
    v_add_f32 v35, v35, v43
    v_add_f32 v28, v28, v32
    v_add_f32 v29, v29, v33
    v_add_f32 v30, v30, v34
    v_add_f32 v31, v31, v35
    v_lshlrev_b32 v44, 16, v54
    v_and_b32 v45, 0xffff0000, v54
    v_lshlrev_b32 v46, 16, v55
    v_and_b32 v47, 0xffff0000, v55
    v_add_f32 v28, v28, v44
    v_add_f32 v29, v29, v45
    v_add_f32 v30, v30, v46
    v_add_f32 v31, v31, v47
    v_cvt_pk_bf16_f32 v54, v28, v29
    v_cvt_pk_bf16_f32 v55, v30, v31
    s_cmp_eq_u32 s72, 0
    s_cbranch_scc1 L_lsh1
    buffer_store_dwordx2 v[54:55], v11, s[20:23], s73 offen offset:1024
L_leh1:
    v_add_f32 v48, v48, v28
    v_fmac_f32 v49, v28, v28
    v_add_f32 v48, v48, v29
    v_fmac_f32 v49, v29, v29
    v_add_f32 v48, v48, v30
    v_fmac_f32 v49, v30, v30
    v_add_f32 v48, v48, v31
    v_fmac_f32 v49, v31, v31
    s_cmp_lg_u32 s69, 0
    s_cbranch_scc1 L_rewo
    s_waitcnt lgkmcnt(1)
    v_add_f32 v56, v56, v64
    v_add_f32 v57, v57, v65
    v_add_f32 v58, v58, v66
    v_add_f32 v59, v59, v67
    s_waitcnt lgkmcnt(0)
    v_add_f32 v60, v60, v68
    v_add_f32 v61, v61, v69
    v_add_f32 v62, v62, v70
    v_add_f32 v63, v63, v71
    v_add_f32 v56, v56, v60
    v_add_f32 v57, v57, v61
    v_add_f32 v58, v58, v62
    v_add_f32 v59, v59, v63
    v_lshlrev_b32 v44, 16, v8
    v_and_b32 v45, 0xffff0000, v8
    v_lshlrev_b32 v46, 16, v9
    v_and_b32 v47, 0xffff0000, v9
    v_add_f32 v56, v56, v44
    v_add_f32 v57, v57, v45
    v_add_f32 v58, v58, v46
    v_add_f32 v59, v59, v47
    v_cvt_pk_bf16_f32 v8, v56, v57
    v_cvt_pk_bf16_f32 v9, v58, v59
    s_cmp_eq_u32 s72, 0
    s_cbranch_scc1 L_lsh2
    buffer_store_dwordx2 v[8:9], v11, s[20:23], s73 offen offset:2048
L_leh2:
    v_add_f32 v48, v48, v56
    v_fmac_f32 v49, v56, v56
    v_add_f32 v48, v48, v57
    v_fmac_f32 v49, v57, v57
    v_add_f32 v48, v48, v58
    v_fmac_f32 v49, v58, v58
    v_add_f32 v48, v48, v59
    v_fmac_f32 v49, v59, v59
L_rewo:
    s_nop 1
    v_mov_b32 v50, v48
    v_mov_b32 v51, v49
    s_nop 1
    v_permlane32_swap_b32 v48, v50
    v_permlane32_swap_b32 v49, v51
    v_add_f32 v48, v48, v50
    v_add_f32 v49, v49, v51
    v_mov_b32 v50, v48
    v_mov_b32 v51, v49
    s_nop 1
    v_permlane16_swap_b32 v48, v50
    v_permlane16_swap_b32 v49, v51
    v_add_f32 v48, v48, v50
    v_add_f32 v49, v49, v51
    s_mov_b64 exec, 0xffff
    s_cmp_eq_u32 s72, 0
    s_cbranch_scc1 L_lshs
    buffer_store_dwordx2 v[48:49], v7, s[20:23], s75 offen
L_lehs:
    s_mov_b64 exec, -1
    s_waitcnt lgkmcnt(0)
    s_lshr_b32 s32, s30, 2
    s_lshl_b32 s32, s32, 3
    s_add_u32 s32, s32, s79
    s_lshl_b32 s32, s32, 2
    s_add_u32 s32, s32, s31
    s_lshl_b32 s32, s32, 2
    s_add_u32 s32, s32, s51
    s_add_u32 s32, s32, 256
    v_mov_b32 v4, 0
    v_mov_b32 v5, s36
    s_mov_b64 exec, 1
    s_waitcnt vmcnt(0)
    s_cmp_eq_u32 s72, 0
    s_cbranch_scc1 L_lsph
    buffer_store_dword v5, v4, s[20:23], s32 offen
L_leph:
    s_mov_b64 exec, -1
    s_setpc_b64 s[52:53]
L_hs:
    s_lshl_b32 s62, s55, 7
    s_add_u32 s62, s62, s51
    s_add_u32 s62, s62, 256
    s_lshl_b32 s32, s55, 5
    s_add_u32 s32, s32, s63
    s_mul_i32 s64, s32, 40960
    s_lshl_b32 s33, s31, 10
    s_add_u32 s64, s64, s33
    s_add_u32 s64, s64, 21495808
    s_add_u32 s65, s33, s59
    v_lshlrev_b32 v4, 2, v1
    s_mov_b32 s42, 0
    s_mov_b64 exec, 4294967295
L_gh:
    buffer_load_dword v5, v4, s[20:23], s62 offen sc1
    s_add_u32 s42, s42, 1
    s_cmp_gt_u32 s42, 0x100000
    s_cbranch_scc1 L_ghx
    s_waitcnt vmcnt(0)
    v_cmp_eq_u32 vcc, s36, v5
    s_cmp_eq_u64 vcc, exec
    s_cbranch_scc0 L_gh
L_ghx:
    s_mov_b64 exec, -1
    s_add_u32 m0, s65, 0
    s_add_u32 s34, s64, 0
    buffer_load_dwordx4 v6, s[20:23], s34 offen sc1 lds
    s_add_u32 m0, s65, 4096
    s_add_u32 s34, s64, 4096
    buffer_load_dwordx4 v6, s[20:23], s34 offen sc1 lds
    s_add_u32 m0, s65, 8192
    s_add_u32 s34, s64, 8192
    buffer_load_dwordx4 v6, s[20:23], s34 offen sc1 lds
    s_add_u32 m0, s65, 12288
    s_add_u32 s34, s64, 12288
    buffer_load_dwordx4 v6, s[20:23], s34 offen sc1 lds
    s_add_u32 m0, s65, 16384
    s_add_u32 s34, s64, 16384
    buffer_load_dwordx4 v6, s[20:23], s34 offen sc1 lds
    s_add_u32 m0, s65, 20480
    s_add_u32 s34, s64, 20480
    buffer_load_dwordx4 v6, s[20:23], s34 offen sc1 lds
    s_add_u32 m0, s65, 24576
    s_add_u32 s34, s64, 24576
    buffer_load_dwordx4 v6, s[20:23], s34 offen sc1 lds
    s_add_u32 m0, s65, 28672
    s_add_u32 s34, s64, 28672
    buffer_load_dwordx4 v6, s[20:23], s34 offen sc1 lds
    s_add_u32 m0, s65, 32768
    s_add_u32 s34, s64, 32768
    buffer_load_dwordx4 v6, s[20:23], s34 offen sc1 lds
    s_add_u32 m0, s65, 36864
    s_add_u32 s34, s64, 36864
    buffer_load_dwordx4 v6, s[20:23], s34 offen sc1 lds
    s_setpc_b64 s[52:53]
L_st:
    s_lshl_b32 s32, s55, 5
    s_add_u32 s32, s32, s63
    s_lshl_b32 s66, s32, 12
    s_add_u32 s66, s66, 24117248
    v_and_b32 v2, 15, v1
    v_lshlrev_b32 v2, 3, v2
    v_bfe_u32 v3, v1, 4, 1
    v_lshl_add_u32 v2, v3, 11, v2
    v_lshrrev_b32 v3, 5, v1
    v_lshl_add_u32 v2, v3, 10, v2
    buffer_load_dwordx2 v[28:29], v2, s[20:23], s66 offen offset:0 sc1
    buffer_load_dwordx2 v[30:31], v2, s[20:23], s66 offen offset:128 sc1
    buffer_load_dwordx2 v[32:33], v2, s[20:23], s66 offen offset:256 sc1
    buffer_load_dwordx2 v[34:35], v2, s[20:23], s66 offen offset:384 sc1
    buffer_load_dwordx2 v[36:37], v2, s[20:23], s66 offen offset:512 sc1
    buffer_load_dwordx2 v[38:39], v2, s[20:23], s66 offen offset:640 sc1
    buffer_load_dwordx2 v[40:41], v2, s[20:23], s66 offen offset:768 sc1
    buffer_load_dwordx2 v[42:43], v2, s[20:23], s66 offen offset:896 sc1
    s_lshl_b32 s32, s55, 8
    s_add_u32 s32, s32, 108544
    v_and_b32 v2, 31, v1
    v_lshl_add_u32 v2, v2, 3, s32
    s_waitcnt vmcnt(0)
    v_add_f32 v28, v28, v36
    v_add_f32 v29, v29, v37
    v_add_f32 v30, v30, v38
    v_add_f32 v31, v31, v39
    v_add_f32 v32, v32, v40
    v_add_f32 v33, v33, v41
    v_add_f32 v34, v34, v42
    v_add_f32 v35, v35, v43
    v_add_f32 v28, v28, v32
    v_add_f32 v29, v29, v33
    v_add_f32 v30, v30, v34
    v_add_f32 v31, v31, v35
    v_add_f32 v28, v28, v30
    v_add_f32 v29, v29, v31
    v_mov_b32 v30, v28
    v_mov_b32 v31, v29
    s_nop 1
    v_permlane32_swap_b32 v28, v30
    v_permlane32_swap_b32 v29, v31
    v_add_f32 v28, v28, v30
    v_add_f32 v29, v29, v31
    v_mul_f32 v28, 0xbacccccd, v28
    v_mul_f32 v29, 0x3acccccd, v29
    v_fma_f32 v29, -v28, v28, v29
    v_max_f32 v29, 0, v29
    v_add_f32 v29, 0x3727c5ac, v29
    v_rsq_f32 v29, v29
    s_nop 0
    ds_write_b64 v2, v[28:29]
    s_setpc_b64 s[52:53]
L_fa:
    v_add_u32 v3, 0, v6
    ds_read_b128 v[28:31], v3 offset:0
    ds_read_b128 v[32:35], v3 offset:1024
    ds_read_b128 v[36:39], v3 offset:2048
    ds_read_b128 v[40:43], v3 offset:3072
    ds_read_b128 v[44:47], v3 offset:4096
    s_waitcnt lgkmcnt(4)
    v_mfma_f32_32x32x16_bf16 v[12:27], v[96:99], v[28:31], 0
    ds_read_b128 v[48:51], v3 offset:5120
    s_waitcnt lgkmcnt(4)
    v_mfma_f32_32x32x16_bf16 v[12:27], v[100:103], v[32:35], v[12:27]
    ds_read_b128 v[28:31], v3 offset:6144
    s_waitcnt lgkmcnt(4)
    v_mfma_f32_32x32x16_bf16 v[12:27], v[104:107], v[36:39], v[12:27]
    ds_read_b128 v[32:35], v3 offset:7168
    s_waitcnt lgkmcnt(4)
    v_mfma_f32_32x32x16_bf16 v[12:27], v[108:111], v[40:43], v[12:27]
    ds_read_b128 v[36:39], v3 offset:8192
    s_waitcnt lgkmcnt(4)
    v_mfma_f32_32x32x16_bf16 v[12:27], v[112:115], v[44:47], v[12:27]
    ds_read_b128 v[40:43], v3 offset:9216
    s_waitcnt lgkmcnt(4)
    v_mfma_f32_32x32x16_bf16 v[12:27], v[116:119], v[48:51], v[12:27]
    ds_read_b128 v[44:47], v3 offset:10240
    s_waitcnt lgkmcnt(4)
    v_mfma_f32_32x32x16_bf16 v[12:27], v[120:123], v[28:31], v[12:27]
    ds_read_b128 v[48:51], v3 offset:11264
    s_waitcnt lgkmcnt(4)
    v_mfma_f32_32x32x16_bf16 v[12:27], v[124:127], v[32:35], v[12:27]
    ds_read_b128 v[28:31], v3 offset:12288
    s_waitcnt lgkmcnt(4)
    v_mfma_f32_32x32x16_bf16 v[12:27], v[128:131], v[36:39], v[12:27]
    ds_read_b128 v[32:35], v3 offset:13312
    s_waitcnt lgkmcnt(4)
    v_mfma_f32_32x32x16_bf16 v[12:27], v[132:135], v[40:43], v[12:27]
    ds_read_b128 v[36:39], v3 offset:14336
    s_waitcnt lgkmcnt(4)
    v_mfma_f32_32x32x16_bf16 v[12:27], v[136:139], v[44:47], v[12:27]
    ds_read_b128 v[40:43], v3 offset:15360
    s_waitcnt lgkmcnt(4)
    v_mfma_f32_32x32x16_bf16 v[12:27], v[140:143], v[48:51], v[12:27]
    ds_read_b128 v[44:47], v3 offset:16384
    s_waitcnt lgkmcnt(4)
    v_mfma_f32_32x32x16_bf16 v[12:27], v[144:147], v[28:31], v[12:27]
    ds_read_b128 v[48:51], v3 offset:17408
    s_waitcnt lgkmcnt(4)
    v_mfma_f32_32x32x16_bf16 v[12:27], v[148:151], v[32:35], v[12:27]
    ds_read_b128 v[28:31], v3 offset:18432
    s_waitcnt lgkmcnt(4)
    v_mfma_f32_32x32x16_bf16 v[12:27], v[152:155], v[36:39], v[12:27]
    ds_read_b128 v[32:35], v3 offset:19456
    s_waitcnt lgkmcnt(4)
    v_mfma_f32_32x32x16_bf16 v[12:27], v[156:159], v[40:43], v[12:27]
    ds_read_b128 v[36:39], v3 offset:20480
    s_waitcnt lgkmcnt(4)
    v_mfma_f32_32x32x16_bf16 v[12:27], v[160:163], v[44:47], v[12:27]
    ds_read_b128 v[40:43], v3 offset:21504
    s_waitcnt lgkmcnt(4)
    v_mfma_f32_32x32x16_bf16 v[12:27], v[164:167], v[48:51], v[12:27]
    ds_read_b128 v[44:47], v3 offset:22528
    s_waitcnt lgkmcnt(4)
    v_mfma_f32_32x32x16_bf16 v[12:27], v[168:171], v[28:31], v[12:27]
    ds_read_b128 v[48:51], v3 offset:23552
    s_waitcnt lgkmcnt(4)
    v_mfma_f32_32x32x16_bf16 v[12:27], v[172:175], v[32:35], v[12:27]
    ds_read_b128 v[28:31], v3 offset:24576
    s_waitcnt lgkmcnt(4)
    v_mfma_f32_32x32x16_bf16 v[12:27], v[176:179], v[36:39], v[12:27]
    ds_read_b128 v[32:35], v3 offset:25600
    s_waitcnt lgkmcnt(4)
    v_mfma_f32_32x32x16_bf16 v[12:27], v[180:183], v[40:43], v[12:27]
    ds_read_b128 v[36:39], v3 offset:26624
    s_waitcnt lgkmcnt(4)
    v_mfma_f32_32x32x16_bf16 v[12:27], v[184:187], v[44:47], v[12:27]
    ds_read_b128 v[40:43], v3 offset:27648
    s_waitcnt lgkmcnt(4)
    v_mfma_f32_32x32x16_bf16 v[12:27], v[188:191], v[48:51], v[12:27]
    ds_read_b128 v[44:47], v3 offset:28672
    s_waitcnt lgkmcnt(4)
    v_mfma_f32_32x32x16_bf16 v[12:27], v[192:195], v[28:31], v[12:27]
    ds_read_b128 v[48:51], v3 offset:29696
    s_waitcnt lgkmcnt(4)
    v_mfma_f32_32x32x16_bf16 v[12:27], v[196:199], v[32:35], v[12:27]
    ds_read_b128 v[28:31], v3 offset:30720
    s_waitcnt lgkmcnt(4)
    v_mfma_f32_32x32x16_bf16 v[12:27], v[200:203], v[36:39], v[12:27]
    ds_read_b128 v[32:35], v3 offset:31744
    s_waitcnt lgkmcnt(4)
    v_mfma_f32_32x32x16_bf16 v[12:27], v[204:207], v[40:43], v[12:27]
    ds_read_b128 v[36:39], v3 offset:32768
    s_waitcnt lgkmcnt(4)
    v_mfma_f32_32x32x16_bf16 v[12:27], v[208:211], v[44:47], v[12:27]
    ds_read_b128 v[40:43], v3 offset:33792
    s_waitcnt lgkmcnt(4)
    v_mfma_f32_32x32x16_bf16 v[12:27], v[212:215], v[48:51], v[12:27]
    ds_read_b128 v[44:47], v3 offset:34816
    s_waitcnt lgkmcnt(4)
    v_mfma_f32_32x32x16_bf16 v[12:27], v[216:219], v[28:31], v[12:27]
    ds_read_b128 v[48:51], v3 offset:35840
    s_waitcnt lgkmcnt(4)
    v_mfma_f32_32x32x16_bf16 v[12:27], v[220:223], v[32:35], v[12:27]
    ds_read_b128 v[28:31], v3 offset:36864
    s_waitcnt lgkmcnt(4)
    v_mfma_f32_32x32x16_bf16 v[12:27], v[224:227], v[36:39], v[12:27]
    ds_read_b128 v[32:35], v3 offset:37888
    s_waitcnt lgkmcnt(4)
    v_mfma_f32_32x32x16_bf16 v[12:27], v[228:231], v[40:43], v[12:27]
    ds_read_b128 v[36:39], v3 offset:38912
    s_waitcnt lgkmcnt(4)
    v_mfma_f32_32x32x16_bf16 v[12:27], v[232:235], v[44:47], v[12:27]
    ds_read_b128 v[40:43], v3 offset:39936
    s_waitcnt lgkmcnt(4)
    v_mfma_f32_32x32x16_bf16 v[12:27], v[236:239], v[48:51], v[12:27]
    s_waitcnt lgkmcnt(3)
    v_mfma_f32_32x32x16_bf16 v[12:27], v[240:243], v[28:31], v[12:27]
    s_waitcnt lgkmcnt(2)
    v_mfma_f32_32x32x16_bf16 v[12:27], v[244:247], v[32:35], v[12:27]
    s_waitcnt lgkmcnt(1)
    v_mfma_f32_32x32x16_bf16 v[12:27], v[248:251], v[36:39], v[12:27]
    s_waitcnt lgkmcnt(0)
    v_mfma_f32_32x32x16_bf16 v[12:27], v[252:255], v[40:43], v[12:27]
    s_setpc_b64 s[52:53]
L_ge:
    s_lshl_b32 s32, s30, 8
    s_add_u32 s32, s32, 106496
    v_lshrrev_b32 v3, 5, v1
    v_lshl_add_u32 v10, v3, 4, s32
    s_lshl_b32 s32, s55, 8
    s_add_u32 s32, s32, 108544
    v_and_b32 v2, 31, v1
    v_lshl_add_u32 v2, v2, 3, s32
    ds_read_b64 v[4:5], v2
    ds_read_b128 v[28:31], v10 offset:0
    ds_read_b128 v[36:39], v10 offset:128
    ds_read_b128 v[32:35], v10 offset:32
    ds_read_b128 v[40:43], v10 offset:160
    v_and_b32 v2, 15, v1
    v_lshlrev_b32 v2, 4, v2
    v_lshl_add_u32 v2, v3, 8, v2
    v_bfe_u32 v3, v1, 4, 1
    v_mul_u32_u24 v3, 55296, v3
    v_add_u32 v2, v2, v3
    s_lshl_b32 s32, s55, 5
    s_add_u32 s32, s32, s63
    s_mul_i32 s32, s32, 108
    s_add_u32 s32, s32, s58
    s_lshl_b32 s32, s32, 10
    s_add_u32 s32, s32, 25165824
    s_mov_b32 s62, 0xbdd2d3e8
    v_mov_b32 v3, 0xc0135761
    s_lshl_b32 s33, s55, 8
    s_add_u32 s33, s33, s61
    s_add_u32 s33, s33, 512
    s_waitcnt lgkmcnt(0)
    v_fmac_f32 v12, v4, v28
    v_fmac_f32 v13, v4, v29
    v_fmac_f32 v14, v4, v30
    v_fmac_f32 v15, v4, v31
    v_fmac_f32 v16, v4, v32
    v_fmac_f32 v17, v4, v33
    v_fmac_f32 v18, v4, v34
    v_fmac_f32 v19, v4, v35
    v_fma_f32 v12, v12, v5, v36
    v_fma_f32 v13, v13, v5, v37
    v_fma_f32 v14, v14, v5, v38
    v_fma_f32 v15, v15, v5, v39
    v_fma_f32 v16, v16, v5, v40
    v_fma_f32 v17, v17, v5, v41
    v_fma_f32 v18, v18, v5, v42
    v_fma_f32 v19, v19, v5, v43
    ds_read_b128 v[28:31], v10 offset:64
    ds_read_b128 v[36:39], v10 offset:192
    ds_read_b128 v[32:35], v10 offset:96
    ds_read_b128 v[40:43], v10 offset:224
    v_mul_f32 v44, v12, v12
    v_mul_f32 v45, v13, v13
    v_mul_f32 v46, v14, v14
    v_mul_f32 v47, v15, v15
    v_mul_f32 v48, v16, v16
    v_mul_f32 v49, v17, v17
    v_mul_f32 v50, v18, v18
    v_mul_f32 v51, v19, v19
    v_fma_f32 v44, v44, s62, v3
    v_fma_f32 v45, v45, s62, v3
    v_fma_f32 v46, v46, s62, v3
    v_fma_f32 v47, v47, s62, v3
    v_fma_f32 v48, v48, s62, v3
    v_fma_f32 v49, v49, s62, v3
    v_fma_f32 v50, v50, s62, v3
    v_fma_f32 v51, v51, s62, v3
    v_mul_f32 v44, v44, v12
    v_mul_f32 v45, v45, v13
    v_mul_f32 v46, v46, v14
    v_mul_f32 v47, v47, v15
    v_mul_f32 v48, v48, v16
    v_mul_f32 v49, v49, v17
    v_mul_f32 v50, v50, v18
    v_mul_f32 v51, v51, v19
    v_exp_f32 v44, v44
    v_exp_f32 v45, v45
    v_exp_f32 v46, v46
    v_exp_f32 v47, v47
    v_exp_f32 v48, v48
    v_exp_f32 v49, v49
    v_exp_f32 v50, v50
    v_exp_f32 v51, v51
    v_add_f32 v44, 1.0, v44
    v_add_f32 v45, 1.0, v45
    v_add_f32 v46, 1.0, v46
    v_add_f32 v47, 1.0, v47
    v_add_f32 v48, 1.0, v48
    v_add_f32 v49, 1.0, v49
    v_add_f32 v50, 1.0, v50
    v_add_f32 v51, 1.0, v51
    v_rcp_f32 v44, v44
    v_rcp_f32 v45, v45
    v_rcp_f32 v46, v46
    v_rcp_f32 v47, v47
    v_rcp_f32 v48, v48
    v_rcp_f32 v49, v49
    v_rcp_f32 v50, v50
    v_rcp_f32 v51, v51
    v_mul_f32 v12, v12, v44
    v_mul_f32 v13, v13, v45
    v_mul_f32 v14, v14, v46
    v_mul_f32 v15, v15, v47
    v_mul_f32 v16, v16, v48
    v_mul_f32 v17, v17, v49
    v_mul_f32 v18, v18, v50
    v_mul_f32 v19, v19, v51
    v_cvt_pk_bf16_f32 v12, v12, v13
    v_cvt_pk_bf16_f32 v13, v14, v15
    v_cvt_pk_bf16_f32 v14, v16, v17
    v_cvt_pk_bf16_f32 v15, v18, v19
    buffer_store_dwordx4 v[12:15], v2, s[20:23], s32 offen offset:0 sc1
    s_waitcnt lgkmcnt(0)
    v_fmac_f32 v20, v4, v28
    v_fmac_f32 v21, v4, v29
    v_fmac_f32 v22, v4, v30
    v_fmac_f32 v23, v4, v31
    v_fmac_f32 v24, v4, v32
    v_fmac_f32 v25, v4, v33
    v_fmac_f32 v26, v4, v34
    v_fmac_f32 v27, v4, v35
    v_fma_f32 v20, v20, v5, v36
    v_fma_f32 v21, v21, v5, v37
    v_fma_f32 v22, v22, v5, v38
    v_fma_f32 v23, v23, v5, v39
    v_fma_f32 v24, v24, v5, v40
    v_fma_f32 v25, v25, v5, v41
    v_fma_f32 v26, v26, v5, v42
    v_fma_f32 v27, v27, v5, v43
    v_mul_f32 v44, v20, v20
    v_mul_f32 v45, v21, v21
    v_mul_f32 v46, v22, v22
    v_mul_f32 v47, v23, v23
    v_mul_f32 v48, v24, v24
    v_mul_f32 v49, v25, v25
    v_mul_f32 v50, v26, v26
    v_mul_f32 v51, v27, v27
    v_fma_f32 v44, v44, s62, v3
    v_fma_f32 v45, v45, s62, v3
    v_fma_f32 v46, v46, s62, v3
    v_fma_f32 v47, v47, s62, v3
    v_fma_f32 v48, v48, s62, v3
    v_fma_f32 v49, v49, s62, v3
    v_fma_f32 v50, v50, s62, v3
    v_fma_f32 v51, v51, s62, v3
    v_mul_f32 v44, v44, v20
    v_mul_f32 v45, v45, v21
    v_mul_f32 v46, v46, v22
    v_mul_f32 v47, v47, v23
    v_mul_f32 v48, v48, v24
    v_mul_f32 v49, v49, v25
    v_mul_f32 v50, v50, v26
    v_mul_f32 v51, v51, v27
    v_exp_f32 v44, v44
    v_exp_f32 v45, v45
    v_exp_f32 v46, v46
    v_exp_f32 v47, v47
    v_exp_f32 v48, v48
    v_exp_f32 v49, v49
    v_exp_f32 v50, v50
    v_exp_f32 v51, v51
    v_add_f32 v44, 1.0, v44
    v_add_f32 v45, 1.0, v45
    v_add_f32 v46, 1.0, v46
    v_add_f32 v47, 1.0, v47
    v_add_f32 v48, 1.0, v48
    v_add_f32 v49, 1.0, v49
    v_add_f32 v50, 1.0, v50
    v_add_f32 v51, 1.0, v51
    v_rcp_f32 v44, v44
    v_rcp_f32 v45, v45
    v_rcp_f32 v46, v46
    v_rcp_f32 v47, v47
    v_rcp_f32 v48, v48
    v_rcp_f32 v49, v49
    v_rcp_f32 v50, v50
    v_rcp_f32 v51, v51
    v_mul_f32 v20, v20, v44
    v_mul_f32 v21, v21, v45
    v_mul_f32 v22, v22, v46
    v_mul_f32 v23, v23, v47
    v_mul_f32 v24, v24, v48
    v_mul_f32 v25, v25, v49
    v_mul_f32 v26, v26, v50
    v_mul_f32 v27, v27, v51
    v_cvt_pk_bf16_f32 v20, v20, v21
    v_cvt_pk_bf16_f32 v21, v22, v23
    v_cvt_pk_bf16_f32 v22, v24, v25
    v_cvt_pk_bf16_f32 v23, v26, v27
    buffer_store_dwordx4 v[20:23], v2, s[20:23], s32 offen offset:512 sc1
    s_cmp_eq_u32 s101, 0
    s_cbranch_scc1 L_gnb
    s_barrier
L_gnb:
    v_mov_b32 v4, 0
    v_mov_b32 v5, s36
    s_mov_b64 exec, 1
    s_waitcnt vmcnt(0)
    s_cmp_eq_u32 s72, 0
    s_cbranch_scc1 L_lspg
    buffer_store_dword v5, v4, s[20:23], s33 offen
L_lepg:
    s_mov_b64 exec, -1
    s_setpc_b64 s[52:53]
L_lspi:
    buffer_store_dword v5, v4, s[20:23], s32 offen sc1
    s_branch L_lepi
L_lspz:
    buffer_store_dword v5, v4, s[20:23], s6 offen sc1
    s_branch L_lepz
L_fel:
    buffer_load_dword v3, v2, s[20:23], s62 offen sc1
    s_add_u32 s42, s42, 1
    s_cmp_gt_u32 s42, 0x100000
    s_cbranch_scc1 L_fex
    s_waitcnt vmcnt(0)
    s_branch L_fec
L_fll:
    buffer_load_dword v3, v2, s[20:23], s62 offen sc1
    s_add_u32 s42, s42, 1
    s_cmp_gt_u32 s42, 0x100000
    s_cbranch_scc1 L_flx
    s_waitcnt vmcnt(0)
    s_branch L_flc
L_lsh0:
    buffer_store_dwordx2 v[52:53], v11, s[20:23], s73 offen offset:0 sc1
    s_branch L_leh0
L_lsh1:
    buffer_store_dwordx2 v[54:55], v11, s[20:23], s73 offen offset:1024 sc1
    s_branch L_leh1
L_lsh2:
    buffer_store_dwordx2 v[8:9], v11, s[20:23], s73 offen offset:2048 sc1
    s_branch L_leh2
L_lshs:
    buffer_store_dwordx2 v[48:49], v7, s[20:23], s75 offen sc1
    s_branch L_lehs
L_lsph:
    buffer_store_dword v5, v4, s[20:23], s32 offen sc1
    s_branch L_leph
L_lspg:
    buffer_store_dword v5, v4, s[20:23], s33 offen sc1
    s_branch L_lepg
L_slow:
    v_and_b32 v2, 31, v1
    v_lshrrev_b32 v3, 5, v1
    v_lshlrev_b32 v8, 12, v3
    v_lshl_add_u32 v8, v2, 3, v8
    v_lshlrev_b32 v9, 3, v2
    v_add_u32 v9, 8192, v9
    v_mul_u32_u24 v10, 10240, v3
    v_lshl_add_u32 v10, v2, 4, v10
    v_add_u32 v11, 20480, v10
    v_mov_b32 v76, 0
    v_mov_b32 v77, 0
    v_mov_b32 v78, 0
    v_mov_b32 v79, 0
    v_mov_b32 v80, 0
    v_mov_b32 v81, 0
    v_mov_b32 v82, 0
    v_mov_b32 v83, 0
    v_mov_b32 v84, 0
    v_mov_b32 v85, 0
    v_mov_b32 v86, 0
    v_mov_b32 v87, 0
    v_mov_b32 v88, 0
    v_mov_b32 v89, 0
    v_mov_b32 v90, 0
    v_mov_b32 v91, 0
    v_mov_b32 v108, 0xff61b1e6
    v_mov_b32 v92, 0
    v_mov_b32 v93, 0
    v_mov_b32 v94, 0
    v_mov_b32 v95, 0
    v_mov_b32 v96, 0
    v_mov_b32 v97, 0
    v_mov_b32 v98, 0
    v_mov_b32 v99, 0
    v_mov_b32 v100, 0
    v_mov_b32 v101, 0
    v_mov_b32 v102, 0
    v_mov_b32 v103, 0
    v_mov_b32 v104, 0
    v_mov_b32 v105, 0
    v_mov_b32 v106, 0
    v_mov_b32 v107, 0
    v_mov_b32 v124, 0xff61b1e6
    s_mov_b32 s35, 0
L_sl:
    s_lshr_b32 s32, s35, 3
    s_lshl_b32 s32, s32, 1
    s_and_b32 s33, s31, 1
    s_add_u32 s32, s32, s33
    s_add_u32 s33, s32, s100
    s_and_b32 s33, s33, 3
    s_and_b32 s32, s32, 4
    s_add_u32 s32, s32, s33
    s_mul_i32 s32, s32, 327680
    s_and_b32 s33, s35, 7
    s_mul_i32 s34, s33, 40960
    s_add_u32 s34, s34, s32
    s_mul_i32 s62, s3, 320
    s_add_u32 s34, s34, s62
    s_add_u32 s34, s34, 5242880
    s_lshl_b32 s33, s33, 8
    s_add_u32 s32, s32, s33
    s_mul_i32 s33, s3, 10240
    s_add_u32 s32, s32, s33
    s_add_u32 s32, s32, 2621440
    buffer_load_dwordx2 v[172:173], v8, s[20:23], s32 offen sc1
    buffer_load_dwordx2 v[174:175], v8, s[20:23], s32 offen offset:2048 sc1
    buffer_load_dwordx2 v[166:167], v9, s[20:23], s32 offen sc1
    s_mov_b64 exec, s[44:45]
    buffer_load_dwordx4 v[176:179], v10, s[20:23], s34 offen sc1
    buffer_load_dwordx4 v[180:183], v11, s[20:23], s34 offen sc1
    s_mov_b64 exec, -1
    s_waitcnt vmcnt(0)
    v_mfma_f32_32x32x16_bf16 v[12:27], v[172:175], v[156:159], 0
    v_mfma_f32_32x32x16_bf16 v[28:43], v[172:175], v[160:163], 0
    s_nop 9
    v_mfma_f32_32x32x4_2b_bf16 v[12:43], v[166:167], v[164:165], v[12:43]
    s_nop 15
    s_nop 3
    v_max3_f32 v140, v12, v13, v14
    v_max3_f32 v142, v28, v29, v30
    v_max3_f32 v140, v140, v15, v16
    v_max3_f32 v142, v142, v31, v32
    v_max3_f32 v140, v140, v17, v18
    v_max3_f32 v142, v142, v33, v34
    v_max3_f32 v140, v140, v19, v20
    v_max3_f32 v142, v142, v35, v36
    v_max3_f32 v140, v140, v21, v22
    v_max3_f32 v142, v142, v37, v38
    v_max3_f32 v140, v140, v23, v24
    v_max3_f32 v142, v142, v39, v40
    v_max3_f32 v140, v140, v25, v26
    v_max3_f32 v142, v142, v41, v42
    v_max_f32 v140, v140, v27
    v_max_f32 v142, v142, v43
    v_mov_b32 v141, v140
    v_mov_b32 v143, v142
    s_nop 0
    v_permlane32_swap_b32 v140, v141
    v_permlane32_swap_b32 v142, v143
    v_max_f32 v140, v140, v141
    v_max_f32 v142, v142, v143
    v_max_f32 v140, v140, v108
    v_sub_f32 v44, v108, v140
    v_mov_b32 v108, v140
    v_exp_f32 v44, v44
    v_sub_f32 v12, v12, v108
    v_sub_f32 v13, v13, v108
    v_sub_f32 v14, v14, v108
    v_sub_f32 v15, v15, v108
    v_sub_f32 v16, v16, v108
    v_sub_f32 v17, v17, v108
    v_sub_f32 v18, v18, v108
    v_sub_f32 v19, v19, v108
    v_sub_f32 v20, v20, v108
    v_sub_f32 v21, v21, v108
    v_sub_f32 v22, v22, v108
    v_sub_f32 v23, v23, v108
    v_sub_f32 v24, v24, v108
    v_sub_f32 v25, v25, v108
    v_sub_f32 v26, v26, v108
    v_sub_f32 v27, v27, v108
    v_exp_f32 v12, v12
    v_exp_f32 v13, v13
    v_exp_f32 v14, v14
    v_exp_f32 v15, v15
    v_exp_f32 v16, v16
    v_exp_f32 v17, v17
    v_exp_f32 v18, v18
    v_exp_f32 v19, v19
    v_exp_f32 v20, v20
    v_exp_f32 v21, v21
    v_exp_f32 v22, v22
    v_exp_f32 v23, v23
    v_exp_f32 v24, v24
    v_exp_f32 v25, v25
    v_exp_f32 v26, v26
    v_exp_f32 v27, v27
    v_mul_f32 v76, v76, v44
    v_mul_f32 v77, v77, v44
    v_mul_f32 v78, v78, v44
    v_mul_f32 v79, v79, v44
    v_mul_f32 v80, v80, v44
    v_mul_f32 v81, v81, v44
    v_mul_f32 v82, v82, v44
    v_mul_f32 v83, v83, v44
    v_mul_f32 v84, v84, v44
    v_mul_f32 v85, v85, v44
    v_mul_f32 v86, v86, v44
    v_mul_f32 v87, v87, v44
    v_mul_f32 v88, v88, v44
    v_mul_f32 v89, v89, v44
    v_mul_f32 v90, v90, v44
    v_mul_f32 v91, v91, v44
    v_max_f32 v142, v142, v124
    v_sub_f32 v45, v124, v142
    v_mov_b32 v124, v142
    v_exp_f32 v45, v45
    v_sub_f32 v28, v28, v124
    v_sub_f32 v29, v29, v124
    v_sub_f32 v30, v30, v124
    v_sub_f32 v31, v31, v124
    v_sub_f32 v32, v32, v124
    v_sub_f32 v33, v33, v124
    v_sub_f32 v34, v34, v124
    v_sub_f32 v35, v35, v124
    v_sub_f32 v36, v36, v124
    v_sub_f32 v37, v37, v124
    v_sub_f32 v38, v38, v124
    v_sub_f32 v39, v39, v124
    v_sub_f32 v40, v40, v124
    v_sub_f32 v41, v41, v124
    v_sub_f32 v42, v42, v124
    v_sub_f32 v43, v43, v124
    v_exp_f32 v28, v28
    v_exp_f32 v29, v29
    v_exp_f32 v30, v30
    v_exp_f32 v31, v31
    v_exp_f32 v32, v32
    v_exp_f32 v33, v33
    v_exp_f32 v34, v34
    v_exp_f32 v35, v35
    v_exp_f32 v36, v36
    v_exp_f32 v37, v37
    v_exp_f32 v38, v38
    v_exp_f32 v39, v39
    v_exp_f32 v40, v40
    v_exp_f32 v41, v41
    v_exp_f32 v42, v42
    v_exp_f32 v43, v43
    v_mul_f32 v92, v92, v45
    v_mul_f32 v93, v93, v45
    v_mul_f32 v94, v94, v45
    v_mul_f32 v95, v95, v45
    v_mul_f32 v96, v96, v45
    v_mul_f32 v97, v97, v45
    v_mul_f32 v98, v98, v45
    v_mul_f32 v99, v99, v45
    v_mul_f32 v100, v100, v45
    v_mul_f32 v101, v101, v45
    v_mul_f32 v102, v102, v45
    v_mul_f32 v103, v103, v45
    v_mul_f32 v104, v104, v45
    v_mul_f32 v105, v105, v45
    v_mul_f32 v106, v106, v45
    v_mul_f32 v107, v107, v45
    v_cvt_pk_bf16_f32 v140, v12, v13
    v_cvt_pk_bf16_f32 v141, v14, v15
    v_cvt_pk_bf16_f32 v142, v16, v17
    v_cvt_pk_bf16_f32 v143, v18, v19
    v_cvt_pk_bf16_f32 v144, v20, v21
    v_cvt_pk_bf16_f32 v145, v22, v23
    v_cvt_pk_bf16_f32 v146, v24, v25
    v_cvt_pk_bf16_f32 v147, v26, v27
    v_cvt_pk_bf16_f32 v148, v28, v29
    v_cvt_pk_bf16_f32 v149, v30, v31
    v_cvt_pk_bf16_f32 v150, v32, v33
    v_cvt_pk_bf16_f32 v151, v34, v35
    v_cvt_pk_bf16_f32 v152, v36, v37
    v_cvt_pk_bf16_f32 v153, v38, v39
    v_cvt_pk_bf16_f32 v154, v40, v41
    v_cvt_pk_bf16_f32 v155, v42, v43
    s_nop 1
    v_mfma_f32_32x32x16_bf16 v[76:91], v[176:179], v[140:143], v[76:91]
    v_mfma_f32_32x32x16_bf16 v[76:91], v[180:183], v[144:147], v[76:91]
    v_mfma_f32_32x32x16_bf16 v[92:107], v[176:179], v[148:151], v[92:107]
    v_mfma_f32_32x32x16_bf16 v[92:107], v[180:183], v[152:155], v[92:107]
    s_add_u32 s35, s35, 1
    s_cmp_lt_u32 s35, 32
    s_nop 9
    s_cbranch_scc1 L_sl
    v_sub_f32 v108, 0, v108
    v_sub_f32 v124, 0, v124
    s_setpc_b64 s[52:53]
L_sequential_preLN__softmax_full_mha__dense_activation_gelu__prompt_kernel_end:
    s_endpgm

.section .rodata,"a"
.p2align 6
.amdhsa_kernel sequential_preLN__softmax_full_mha__dense_activation_gelu__prompt_kernel
  .amdhsa_next_free_vgpr 256
  .amdhsa_next_free_sgpr 102
  .amdhsa_accum_offset 256
  .amdhsa_group_segment_fixed_size 0
  .amdhsa_kernarg_size 88
  .amdhsa_user_sgpr_count 2
  .amdhsa_user_sgpr_kernarg_segment_ptr 1
  .amdhsa_system_sgpr_workgroup_id_x 1
.end_amdhsa_kernel
```
